```python
import torch

def _softmax(x, axis=-1):
    return torch.softmax(x, dim=axis)

def _gelu(x):
    return torch.nn.functional.gelu(x, approximate='tanh')

def _silu(x):
    return torch.nn.functional.silu(x)

def _sigmoid(x):
    return torch.sigmoid(x)

def _layernorm(x, axis=-1, eps=1e-05):
    m = x.mean(dim=axis, keepdim=True)
    v = x.var(dim=axis, keepdim=True, unbiased=False)
    return (x - m) / torch.sqrt(v + eps)

def _scatter_add(tgt, idx, src, axis=0):
    return tgt.clone().index_add_(axis, idx, src)

def _segment_sum(src, seg, n):
    out = torch.zeros((n,) + src.shape[1:], dtype=src.dtype)
    return out.index_add_(0, seg, src)

def _pad(x, pw):
    flat = tuple((v for pair in reversed(pw) for v in pair))
    return torch.nn.functional.pad(x, flat)
kernel_name = 'recurrent_scan__sliding_local_dilated__mixer_gmlp__prompt'

def setup_inputs():

    _w = lambda a: (lambda t: t.to(torch.bfloat16) if t.is_floating_point() else t)(torch.as_tensor(a))

    def _A_setup():
        B, S, D = (1, 2048, 512)
        return {'x': _w((lambda *s: torch.randn(*s, dtype=torch.bfloat16) * 0.05)(B, S, D)), 'wqkv': _w((lambda *s: torch.randn(*s, dtype=torch.bfloat16) * 0.05)(D, 3 * D)), 'wo': _w((lambda *s: torch.randn(*s, dtype=torch.bfloat16) * 0.05)(D, D))}
    _A_in = _A_setup()

    def _B_setup():
        B, S, D, F = (1, 2048, 512, 1376)
        Fh = F // 2
        return {'x': _w((lambda *s: torch.randn(*s, dtype=torch.bfloat16) * 0.05)(B, S, D)), 'w_in': _w((lambda *s: torch.randn(*s, dtype=torch.bfloat16) * 0.4)(D, 2 * Fh)), 'w_sp': _w(0.01 * (lambda *s: torch.randn(*s, dtype=torch.bfloat16) * 0.4)(S, S)), 'b_sp': _w(1.0 + 0.01 * (lambda *s: torch.randn(*s, dtype=torch.bfloat16) * 0.05)(S)), 'w_out': _w((lambda *s: torch.randn(*s, dtype=torch.bfloat16) * 0.05)(Fh, D))}
    _B_in = _B_setup()
    return {'A_x': _A_in['x'], 'A_wqkv': _A_in['wqkv'], 'A_wo': _A_in['wo'], 'B_x': _B_in['x'], 'B_w_in': _B_in['w_in'], 'B_w_sp': _B_in['w_sp'], 'B_b_sp': _B_in['b_sp'], 'B_w_out': _B_in['w_out']}

def reference(A_x, A_wqkv, A_wo, B_x, B_w_in, B_w_sp, B_b_sp, B_w_out):

    def _A_ref(x, wqkv, wo):
        B, S, D = x.shape
        H = 32
        Dh = D // H
        W, dil = (8, 2)
        qkv = (lambda x, *d: x.permute(*d))((x @ wqkv).reshape(B, S, 3, H, Dh), 2, 0, 3, 1, 4)
        q, k, v = (qkv[0], qkv[1], qkv[2])
        scale = Dh ** (-0.5)
        pos = torch.arange(S)
        off = torch.arange(W) * dil
        idx = pos[:, None] - off[None, :]
        mask = idx >= 0
        idx_c = torch.where(mask, idx, 0).reshape(-1)
        kg = k[:, :, idx_c, :].reshape(B, H, S, W, Dh)
        vg = v[:, :, idx_c, :].reshape(B, H, S, W, Dh)
        logits = torch.einsum('bhsd,bhswd->bhsw', q, kg) * scale
        logits = torch.where(mask[None, None, :, :], logits, -1000000000.0)
        attn = _softmax(logits, axis=-1)
        o = torch.einsum('bhsw,bhswd->bhsd', attn, vg)
        return (lambda x, *d: x.permute(*d))(o, 0, 2, 1, 3).reshape(B, S, D) @ wo

    def _B_ref(x, w_in, w_sp, b_sp, w_out):
        B, S, D = x.shape
        F = w_in.shape[-1]
        Fh = F // 2
        z = _gelu(torch.einsum('bsd,df->bsf', x, w_in))
        z1 = z[..., :Fh].clone()
        z2 = _layernorm(z[..., Fh:], axis=-1)
        g = torch.einsum('ts,bsf->btf', w_sp, z2) + b_sp[None, :, None]
        return torch.einsum('bsf,fd->bsd', z1 * g, w_out)
    x = A_x
    xn = _layernorm(x, axis=-1)
    s = _A_ref(xn, A_wqkv, A_wo)
    g = _silu(_B_ref(xn, B_w_in, B_w_sp, B_b_sp, B_w_out))
    return x + s * g
```

```asm
; @launch grid=(256,1,1) block=(512,1,1) lds=163840
.amdgcn_target "amdgcn-amd-amdhsa--gfx950"
.text
.globl recurrent_scan__sliding_local_dilated__mixer_gmlp__prompt_kernel
.p2align 8
.type recurrent_scan__sliding_local_dilated__mixer_gmlp__prompt_kernel,@function
recurrent_scan__sliding_local_dilated__mixer_gmlp__prompt_kernel:
    s_cmp_ge_u32 s2, 0x100
    s_cbranch_scc1 L_end
    s_load_dwordx2 s[8:9], s[0:1], 0
    v_readfirstlane_b32 s76, v0
    s_lshr_b32 s96, s2, 3
    s_lshr_b32 s76, s76, 6
    s_and_b32 s84, s96, 7
    s_cmp_lg_u32 s84, s76
    s_cbranch_scc1 L_nopf
    s_getpc_b64 s[98:99]
L_pc:
    v_lshlrev_b32 v37, 7, v0
    v_min_u32 v37, L_end-L_pc, v37
    global_load_dword v255, v37, s[98:99]
L_nopf:
    v_and_b32 v3, 15, v0
    v_lshrrev_b32 v2, 4, v0
    s_bfe_u32 s72, s2, 0x20001
    s_lshr_b32 s84, s2, 5
    s_lshl3_add_u32 s72, s72, s84
    v_lshlrev_b32 v36, 4, v3
    s_lshl_b32 s70, s72, 16
    s_lshl_b32 s10, 1, 21
    s_mov_b32 s11, 0x20000
    v_lshl_add_u32 v36, v2, 10, v36
    s_waitcnt lgkmcnt(0)
    buffer_load_dwordx4 v[4:7], v36, s[8:11], s70 offen offset:0
    buffer_load_dwordx4 v[8:11], v36, s[8:11], s70 offen offset:256
    buffer_load_dwordx4 v[12:15], v36, s[8:11], s70 offen offset:512
    buffer_load_dwordx4 v[16:19], v36, s[8:11], s70 offen offset:768
    s_add_u32 s71, s70, 0x8000
    s_lshl_b32 s81, s72, 6
    v_and_b32 v1, 63, v0
    v_and_b32 v2, 3, v2
    s_load_dwordx2 s[20:21], s[0:1], 32
    s_load_dwordx16 s[48:63], s[0:1], 0
    s_load_dwordx4 s[64:67], s[0:1], 64
    s_load_dwordx2 s[68:69], s[0:1], 80
    s_memrealtime s[94:95]
    buffer_load_dwordx4 v[20:23], v36, s[8:11], s71 offen offset:0
    buffer_load_dwordx4 v[24:27], v36, s[8:11], s71 offen offset:256
    buffer_load_dwordx4 v[28:31], v36, s[8:11], s71 offen offset:512
    buffer_load_dwordx4 v[32:35], v36, s[8:11], s71 offen offset:768
    s_mov_b32 s22, 0x158000
    s_mov_b32 s23, 0x20000
    s_and_b32 s97, s2, 1
    s_lshl_b32 s73, s97, 2
    s_and_b32 s84, s96, 3
    s_add_u32 s73, s73, s84
    s_and_b32 s77, s76, 3
    s_lshr_b32 s75, 0x25, s73
    s_and_b32 s75, s75, 1
    s_mul_i32 s83, s77, 88064
    s_lshl_b32 s84, s75, 1
    s_add_u32 s84, s84, 10
    s_movk_i32 s85, 2752
    v_bfrev_b32 v42, 1
    v_mul_u32_u24 v41, 0xaaab, v1
    v_lshrrev_b32 v41, 19, v41
    v_mad_i32_i24 v40, v41, -12, v1
    v_lshrrev_b32 v37, 2, v41
    v_bitop3_b32 v40, v40, v37, 2 bitop3:0x78
    v_lshl_add_u32 v37, v40, 4, s83
    v_cmp_gt_u32 vcc, s84, v40
    v_mad_u32_u24 v37, v41, s85, v37
    s_nop 0
    v_cndmask_b32 v37, v42, v37, vcc
    v_add_u32 v40, 64, v1
    s_sub_u32 s83, s83, 1024
    v_mul_u32_u24 v41, 0xaaab, v40
    v_lshrrev_b32 v41, 19, v41
    v_mad_i32_i24 v40, v41, -12, v40
    v_lshrrev_b32 v38, 2, v41
    v_bitop3_b32 v40, v40, v38, 2 bitop3:0x78
    v_lshl_add_u32 v38, v40, 4, s83
    v_cmp_gt_u32 vcc, s84, v40
    v_mad_u32_u24 v38, v41, s85, v38
    s_nop 0
    v_cndmask_b32 v38, v42, v38, vcc
    v_add_u32 v40, 128, v1
    s_sub_u32 s83, s83, 1024
    v_mul_u32_u24 v41, 0xaaab, v40
    v_lshrrev_b32 v41, 19, v41
    v_mad_i32_i24 v40, v41, -12, v40
    v_lshrrev_b32 v39, 2, v41
    v_bitop3_b32 v40, v40, v39, 2 bitop3:0x78
    v_lshl_add_u32 v39, v40, 4, s83
    v_cmp_gt_u32 vcc, s84, v40
    v_mad_u32_u24 v39, v41, s85, v39
    s_nop 0
    v_cndmask_b32 v39, v42, v39, vcc
    s_bfm_b32 s84, s73, 0
    s_and_b32 s84, s84, 0x25
    s_bcnt1_i32_b32 s84, s84
    s_mul_i32 s74, s73, 5
    s_add_u32 s74, s74, s84
    s_and_b32 s79, s76, 1
    s_lshr_b32 s80, s77, 1
    s_lshl_b32 s91, s74, 5
    s_mul_i32 s87, s77, 6144
    s_bfe_u32 s100, s2, 0x20005
    s_lshl_b32 s101, s100, 8
    s_waitcnt lgkmcnt(0)
    s_mov_b64 s[12:13], s[50:51]
    s_mov_b32 s14, 0x180000
    s_mov_b32 s15, 0x20000
    s_mov_b64 s[16:17], s[52:53]
    s_mov_b32 s18, 0x80000
    s_mov_b32 s19, 0x20000
    s_mov_b64 s[24:25], s[58:59]
    s_mov_b32 s26, 0x800000
    s_mov_b32 s27, 0x20000
    s_mov_b64 s[28:29], s[60:61]
    s_mov_b32 s30, 0x1000
    s_mov_b32 s31, 0x20000
    s_mov_b64 s[32:33], s[62:63]
    s_mov_b32 s34, 0xac000
    s_mov_b32 s35, 0x20000
    s_mov_b64 s[36:37], s[64:65]
    s_mov_b32 s38, 0x200000
    s_mov_b32 s39, 0x20000
    s_mov_b64 s[40:41], s[66:67]
    s_mov_b32 s42, 0x100
    s_mov_b32 s43, 0x20000
    s_mov_b64 s[44:45], s[68:69]
    s_mov_b32 s46, 0x4000000
    s_mov_b32 s47, 0x20000
    s_mov_b32 s82, s76
L_warm:
    s_mov_b64 exec, 0
    s_cmp_eq_u32 s82, 0
    s_cbranch_scc1 L_pg0
    s_cmp_eq_u32 s82, 1
    s_cbranch_scc1 L_pg1
    s_cmp_eq_u32 s82, 2
    s_cbranch_scc1 L_pg2
    s_cmp_eq_u32 s82, 3
    s_cbranch_scc1 L_pg3
    s_cmp_eq_u32 s82, 4
    s_cbranch_scc1 L_pg4
    s_cmp_eq_u32 s82, 5
    s_cbranch_scc1 L_pg5
    s_cmp_eq_u32 s82, 6
    s_cbranch_scc1 L_pg6
    s_cmp_eq_u32 s82, 7
    s_cbranch_scc1 L_pg7
L_warmed:
    s_mov_b64 exec, -1
    s_add_u32 s82, s82, 8
    s_cmp_lt_u32 s82, 8
    s_cbranch_scc1 L_warm
    s_cmp_lg_u32 s2, 0
    s_cbranch_scc1 L_nononce
    s_cmp_lg_u32 s76, 0
    s_cbranch_scc1 L_nononce
    s_or_b32 s82, s94, 1
    s_mul_i32 s82, s82, 0x9e3779b1
    v_mov_b32 v36, s82
    v_mov_b32 v40, 0
    s_mov_b64 exec, 1
    buffer_store_dword v36, v40, s[40:43], 0 offen sc1
    s_mov_b64 exec, -1
L_nononce:
    s_lshl_b32 s82, s76, 2
    v_add_u32 v40, s82, v2
    v_and_b32 v36, 1, v40
    v_lshlrev_b32 v36, 14, v36
    v_add_u32 v36, 0x18000, v36
    v_lshrrev_b32 v40, 1, v40
    v_xor_b32 v41, v3, v40
    v_lshl_add_u32 v36, v40, 10, v36
    v_lshl_add_u32 v36, v41, 4, v36
    s_cmp_ge_u32 s76, 4
    s_cbranch_scc1 L_noza
    v_xor_b32 v40, v2, v3
    v_lshlrev_b32 v40, 4, v40
    v_lshl_add_u32 v40, v3, 10, v40
    s_lshl_b32 s82, s79, 15
    s_add_u32 s82, s82, 0x18000
    v_add_u32 v40, s82, v40
    v_xor_b32 v41, 64, v40
    v_xor_b32 v42, 128, v40
    v_xor_b32 v43, 192, v40
    v_and_b32 v46, 1, v2
    v_lshrrev_b32 v47, 2, v3
    v_lshl_add_u32 v47, v2, 3, v47
    v_mul_u32_u24 v44, 192, v47
    v_and_b32 v47, 3, v3
    v_lshl_add_u32 v44, v47, 3, v44
    s_mul_i32 s82, s80, 3
    s_add_u32 s83, s82, 1
    v_xor_b32 v47, s83, v46
    v_lshl_add_u32 v45, v47, 5, v44
    v_xor_b32 v47, s82, v46
    v_lshl_add_u32 v44, v47, 5, v44
    v_add_u32 v46, 6144, v44
    v_add_u32 v47, 6144, v45
L_noza:
    s_waitcnt vmcnt(4)
    s_mov_b32 s89, 0x3f803f80
    s_mov_b32 s90, 0xffff0000
    v_mov_b32 v80, 0
    v_mov_b32 v81, 0
    v_dot2c_f32_bf16 v80, s89, v4
    v_dot2c_f32_bf16 v81, v4, v4
    v_dot2c_f32_bf16 v80, s89, v5
    v_dot2c_f32_bf16 v81, v5, v5
    v_dot2c_f32_bf16 v80, s89, v6
    v_dot2c_f32_bf16 v81, v6, v6
    v_dot2c_f32_bf16 v80, s89, v7
    v_dot2c_f32_bf16 v81, v7, v7
    v_dot2c_f32_bf16 v80, s89, v8
    v_dot2c_f32_bf16 v81, v8, v8
    v_dot2c_f32_bf16 v80, s89, v9
    v_dot2c_f32_bf16 v81, v9, v9
    v_dot2c_f32_bf16 v80, s89, v10
    v_dot2c_f32_bf16 v81, v10, v10
    v_dot2c_f32_bf16 v80, s89, v11
    v_dot2c_f32_bf16 v81, v11, v11
    v_dot2c_f32_bf16 v80, s89, v12
    v_dot2c_f32_bf16 v81, v12, v12
    v_dot2c_f32_bf16 v80, s89, v13
    v_dot2c_f32_bf16 v81, v13, v13
    v_dot2c_f32_bf16 v80, s89, v14
    v_dot2c_f32_bf16 v81, v14, v14
    v_dot2c_f32_bf16 v80, s89, v15
    v_dot2c_f32_bf16 v81, v15, v15
    v_dot2c_f32_bf16 v80, s89, v16
    v_dot2c_f32_bf16 v81, v16, v16
    v_dot2c_f32_bf16 v80, s89, v17
    v_dot2c_f32_bf16 v81, v17, v17
    v_dot2c_f32_bf16 v80, s89, v18
    v_dot2c_f32_bf16 v81, v18, v18
    v_dot2c_f32_bf16 v80, s89, v19
    v_dot2c_f32_bf16 v81, v19, v19
    v_lshlrev_b32 v48, 16, v4
    v_and_b32 v49, s90, v4
    v_lshlrev_b32 v50, 16, v5
    v_add_f32_dpp v80, v80, v80 row_ror:8 row_mask:0xf bank_mask:0xf
    v_and_b32 v51, s90, v5
    v_lshlrev_b32 v52, 16, v6
    v_add_f32_dpp v81, v81, v81 row_ror:8 row_mask:0xf bank_mask:0xf
    v_and_b32 v53, s90, v6
    v_lshlrev_b32 v54, 16, v7
    v_add_f32_dpp v80, v80, v80 row_ror:4 row_mask:0xf bank_mask:0xf
    v_and_b32 v55, s90, v7
    v_lshlrev_b32 v56, 16, v8
    v_add_f32_dpp v81, v81, v81 row_ror:4 row_mask:0xf bank_mask:0xf
    v_and_b32 v57, s90, v8
    v_lshlrev_b32 v58, 16, v9
    v_add_f32_dpp v80, v80, v80 row_ror:2 row_mask:0xf bank_mask:0xf
    v_and_b32 v59, s90, v9
    v_lshlrev_b32 v60, 16, v10
    v_add_f32_dpp v81, v81, v81 row_ror:2 row_mask:0xf bank_mask:0xf
    v_and_b32 v61, s90, v10
    v_lshlrev_b32 v62, 16, v11
    v_add_f32_dpp v80, v80, v80 row_ror:1 row_mask:0xf bank_mask:0xf
    v_and_b32 v63, s90, v11
    v_lshlrev_b32 v64, 16, v12
    v_add_f32_dpp v81, v81, v81 row_ror:1 row_mask:0xf bank_mask:0xf
    v_and_b32 v65, s90, v12
    v_lshlrev_b32 v66, 16, v13
    v_mul_f32 v80, 0x3b000000, v80
    v_and_b32 v67, s90, v13
    v_lshlrev_b32 v68, 16, v14
    v_mul_f32 v81, 0x3b000000, v81
    v_and_b32 v69, s90, v14
    v_lshlrev_b32 v70, 16, v15
    v_fma_f32 v81, -v80, v80, v81
    v_and_b32 v71, s90, v15
    v_lshlrev_b32 v72, 16, v16
    v_max_f32 v81, 0, v81
    v_and_b32 v73, s90, v16
    v_lshlrev_b32 v74, 16, v17
    v_add_f32 v81, 0x3727c5ac, v81
    v_and_b32 v75, s90, v17
    v_lshlrev_b32 v76, 16, v18
    v_rsq_f32 v82, v81
    v_and_b32 v77, s90, v18
    v_lshlrev_b32 v78, 16, v19
    v_mul_f32 v83, -v80, v82
    v_and_b32 v79, s90, v19
    v_pk_fma_f32 v[48:49], v[48:49], v[82:83], v[82:83] op_sel:[0,0,1] op_sel_hi:[1,0,1]
    v_pk_fma_f32 v[50:51], v[50:51], v[82:83], v[82:83] op_sel:[0,0,1] op_sel_hi:[1,0,1]
    v_pk_fma_f32 v[52:53], v[52:53], v[82:83], v[82:83] op_sel:[0,0,1] op_sel_hi:[1,0,1]
    v_pk_fma_f32 v[54:55], v[54:55], v[82:83], v[82:83] op_sel:[0,0,1] op_sel_hi:[1,0,1]
    v_cvt_pk_bf16_f32 v4, v48, v49
    v_cvt_pk_bf16_f32 v5, v50, v51
    v_cvt_pk_bf16_f32 v6, v52, v53
    v_cvt_pk_bf16_f32 v7, v54, v55
    ds_write_b128 v36, v[4:7] offset:0
    v_pk_fma_f32 v[56:57], v[56:57], v[82:83], v[82:83] op_sel:[0,0,1] op_sel_hi:[1,0,1]
    v_pk_fma_f32 v[58:59], v[58:59], v[82:83], v[82:83] op_sel:[0,0,1] op_sel_hi:[1,0,1]
    v_pk_fma_f32 v[60:61], v[60:61], v[82:83], v[82:83] op_sel:[0,0,1] op_sel_hi:[1,0,1]
    v_pk_fma_f32 v[62:63], v[62:63], v[82:83], v[82:83] op_sel:[0,0,1] op_sel_hi:[1,0,1]
    v_cvt_pk_bf16_f32 v8, v56, v57
    v_cvt_pk_bf16_f32 v9, v58, v59
    v_cvt_pk_bf16_f32 v10, v60, v61
    v_cvt_pk_bf16_f32 v11, v62, v63
    ds_write_b128 v36, v[8:11] offset:256
    v_pk_fma_f32 v[64:65], v[64:65], v[82:83], v[82:83] op_sel:[0,0,1] op_sel_hi:[1,0,1]
    v_pk_fma_f32 v[66:67], v[66:67], v[82:83], v[82:83] op_sel:[0,0,1] op_sel_hi:[1,0,1]
    v_pk_fma_f32 v[68:69], v[68:69], v[82:83], v[82:83] op_sel:[0,0,1] op_sel_hi:[1,0,1]
    v_pk_fma_f32 v[70:71], v[70:71], v[82:83], v[82:83] op_sel:[0,0,1] op_sel_hi:[1,0,1]
    v_cvt_pk_bf16_f32 v12, v64, v65
    v_cvt_pk_bf16_f32 v13, v66, v67
    v_cvt_pk_bf16_f32 v14, v68, v69
    v_cvt_pk_bf16_f32 v15, v70, v71
    ds_write_b128 v36, v[12:15] offset:512
    v_pk_fma_f32 v[72:73], v[72:73], v[82:83], v[82:83] op_sel:[0,0,1] op_sel_hi:[1,0,1]
    v_pk_fma_f32 v[74:75], v[74:75], v[82:83], v[82:83] op_sel:[0,0,1] op_sel_hi:[1,0,1]
    v_pk_fma_f32 v[76:77], v[76:77], v[82:83], v[82:83] op_sel:[0,0,1] op_sel_hi:[1,0,1]
    v_pk_fma_f32 v[78:79], v[78:79], v[82:83], v[82:83] op_sel:[0,0,1] op_sel_hi:[1,0,1]
    v_cvt_pk_bf16_f32 v16, v72, v73
    v_cvt_pk_bf16_f32 v17, v74, v75
    v_cvt_pk_bf16_f32 v18, v76, v77
    v_cvt_pk_bf16_f32 v19, v78, v79
    ds_write_b128 v36, v[16:19] offset:768
    s_waitcnt vmcnt(0)
    s_cmp_ge_u32 s76, 4
    s_cbranch_scc1 L_now0
    s_add_u32 m0, s87, 0
    s_xor_b32 s85, s100, 0
    s_mul_i32 s85, s85, 352256
    s_add_u32 s86, s91, s85
    s_add_u32 s86, s86, 1376
    buffer_load_dwordx4 v37, s[20:23], s86 offen offset:0 lds
    buffer_load_dwordx4 v38, s[20:23], s86 offen offset:1024 lds
    buffer_load_dwordx4 v39, s[20:23], s86 offen offset:2048 lds
    s_add_u32 m0, s87, 3072
    s_add_u32 s86, s86, 44032
    buffer_load_dwordx4 v37, s[20:23], s86 offen offset:0 lds
    buffer_load_dwordx4 v38, s[20:23], s86 offen offset:1024 lds
    buffer_load_dwordx4 v39, s[20:23], s86 offen offset:2048 lds
L_now0:
    s_mov_b32 s89, 0x3f803f80
    s_mov_b32 s90, 0xffff0000
    v_mov_b32 v80, 0
    v_mov_b32 v81, 0
    v_dot2c_f32_bf16 v80, s89, v20
    v_dot2c_f32_bf16 v81, v20, v20
    v_dot2c_f32_bf16 v80, s89, v21
    v_dot2c_f32_bf16 v81, v21, v21
    v_dot2c_f32_bf16 v80, s89, v22
    v_dot2c_f32_bf16 v81, v22, v22
    v_dot2c_f32_bf16 v80, s89, v23
    v_dot2c_f32_bf16 v81, v23, v23
    v_dot2c_f32_bf16 v80, s89, v24
    v_dot2c_f32_bf16 v81, v24, v24
    v_dot2c_f32_bf16 v80, s89, v25
    v_dot2c_f32_bf16 v81, v25, v25
    v_dot2c_f32_bf16 v80, s89, v26
    v_dot2c_f32_bf16 v81, v26, v26
    v_dot2c_f32_bf16 v80, s89, v27
    v_dot2c_f32_bf16 v81, v27, v27
    v_dot2c_f32_bf16 v80, s89, v28
    v_dot2c_f32_bf16 v81, v28, v28
    v_dot2c_f32_bf16 v80, s89, v29
    v_dot2c_f32_bf16 v81, v29, v29
    v_dot2c_f32_bf16 v80, s89, v30
    v_dot2c_f32_bf16 v81, v30, v30
    v_dot2c_f32_bf16 v80, s89, v31
    v_dot2c_f32_bf16 v81, v31, v31
    v_dot2c_f32_bf16 v80, s89, v32
    v_dot2c_f32_bf16 v81, v32, v32
    v_dot2c_f32_bf16 v80, s89, v33
    v_dot2c_f32_bf16 v81, v33, v33
    v_dot2c_f32_bf16 v80, s89, v34
    v_dot2c_f32_bf16 v81, v34, v34
    v_dot2c_f32_bf16 v80, s89, v35
    v_dot2c_f32_bf16 v81, v35, v35
    v_lshlrev_b32 v48, 16, v20
    v_and_b32 v49, s90, v20
    v_lshlrev_b32 v50, 16, v21
    v_add_f32_dpp v80, v80, v80 row_ror:8 row_mask:0xf bank_mask:0xf
    v_and_b32 v51, s90, v21
    v_lshlrev_b32 v52, 16, v22
    v_add_f32_dpp v81, v81, v81 row_ror:8 row_mask:0xf bank_mask:0xf
    v_and_b32 v53, s90, v22
    v_lshlrev_b32 v54, 16, v23
    v_add_f32_dpp v80, v80, v80 row_ror:4 row_mask:0xf bank_mask:0xf
    v_and_b32 v55, s90, v23
    v_lshlrev_b32 v56, 16, v24
    v_add_f32_dpp v81, v81, v81 row_ror:4 row_mask:0xf bank_mask:0xf
    v_and_b32 v57, s90, v24
    v_lshlrev_b32 v58, 16, v25
    v_add_f32_dpp v80, v80, v80 row_ror:2 row_mask:0xf bank_mask:0xf
    v_and_b32 v59, s90, v25
    v_lshlrev_b32 v60, 16, v26
    v_add_f32_dpp v81, v81, v81 row_ror:2 row_mask:0xf bank_mask:0xf
    v_and_b32 v61, s90, v26
    v_lshlrev_b32 v62, 16, v27
    v_add_f32_dpp v80, v80, v80 row_ror:1 row_mask:0xf bank_mask:0xf
    v_and_b32 v63, s90, v27
    v_lshlrev_b32 v64, 16, v28
    v_add_f32_dpp v81, v81, v81 row_ror:1 row_mask:0xf bank_mask:0xf
    v_and_b32 v65, s90, v28
    v_lshlrev_b32 v66, 16, v29
    v_mul_f32 v80, 0x3b000000, v80
    v_and_b32 v67, s90, v29
    v_lshlrev_b32 v68, 16, v30
    v_mul_f32 v81, 0x3b000000, v81
    v_and_b32 v69, s90, v30
    v_lshlrev_b32 v70, 16, v31
    v_fma_f32 v81, -v80, v80, v81
    v_and_b32 v71, s90, v31
    v_lshlrev_b32 v72, 16, v32
    v_max_f32 v81, 0, v81
    v_and_b32 v73, s90, v32
    v_lshlrev_b32 v74, 16, v33
    v_add_f32 v81, 0x3727c5ac, v81
    v_and_b32 v75, s90, v33
    v_lshlrev_b32 v76, 16, v34
    v_rsq_f32 v82, v81
    v_and_b32 v77, s90, v34
    v_lshlrev_b32 v78, 16, v35
    v_mul_f32 v83, -v80, v82
    v_and_b32 v79, s90, v35
    v_pk_fma_f32 v[48:49], v[48:49], v[82:83], v[82:83] op_sel:[0,0,1] op_sel_hi:[1,0,1]
    v_pk_fma_f32 v[50:51], v[50:51], v[82:83], v[82:83] op_sel:[0,0,1] op_sel_hi:[1,0,1]
    v_pk_fma_f32 v[52:53], v[52:53], v[82:83], v[82:83] op_sel:[0,0,1] op_sel_hi:[1,0,1]
    v_pk_fma_f32 v[54:55], v[54:55], v[82:83], v[82:83] op_sel:[0,0,1] op_sel_hi:[1,0,1]
    v_cvt_pk_bf16_f32 v20, v48, v49
    v_cvt_pk_bf16_f32 v21, v50, v51
    v_cvt_pk_bf16_f32 v22, v52, v53
    v_cvt_pk_bf16_f32 v23, v54, v55
    ds_write_b128 v36, v[20:23] offset:32768
    v_pk_fma_f32 v[56:57], v[56:57], v[82:83], v[82:83] op_sel:[0,0,1] op_sel_hi:[1,0,1]
    v_pk_fma_f32 v[58:59], v[58:59], v[82:83], v[82:83] op_sel:[0,0,1] op_sel_hi:[1,0,1]
    v_pk_fma_f32 v[60:61], v[60:61], v[82:83], v[82:83] op_sel:[0,0,1] op_sel_hi:[1,0,1]
    v_pk_fma_f32 v[62:63], v[62:63], v[82:83], v[82:83] op_sel:[0,0,1] op_sel_hi:[1,0,1]
    v_cvt_pk_bf16_f32 v24, v56, v57
    v_cvt_pk_bf16_f32 v25, v58, v59
    v_cvt_pk_bf16_f32 v26, v60, v61
    v_cvt_pk_bf16_f32 v27, v62, v63
    ds_write_b128 v36, v[24:27] offset:33024
    v_pk_fma_f32 v[64:65], v[64:65], v[82:83], v[82:83] op_sel:[0,0,1] op_sel_hi:[1,0,1]
    v_pk_fma_f32 v[66:67], v[66:67], v[82:83], v[82:83] op_sel:[0,0,1] op_sel_hi:[1,0,1]
    v_pk_fma_f32 v[68:69], v[68:69], v[82:83], v[82:83] op_sel:[0,0,1] op_sel_hi:[1,0,1]
    v_pk_fma_f32 v[70:71], v[70:71], v[82:83], v[82:83] op_sel:[0,0,1] op_sel_hi:[1,0,1]
    v_cvt_pk_bf16_f32 v28, v64, v65
    v_cvt_pk_bf16_f32 v29, v66, v67
    v_cvt_pk_bf16_f32 v30, v68, v69
    v_cvt_pk_bf16_f32 v31, v70, v71
    ds_write_b128 v36, v[28:31] offset:33280
    v_pk_fma_f32 v[72:73], v[72:73], v[82:83], v[82:83] op_sel:[0,0,1] op_sel_hi:[1,0,1]
    v_pk_fma_f32 v[74:75], v[74:75], v[82:83], v[82:83] op_sel:[0,0,1] op_sel_hi:[1,0,1]
    v_pk_fma_f32 v[76:77], v[76:77], v[82:83], v[82:83] op_sel:[0,0,1] op_sel_hi:[1,0,1]
    v_pk_fma_f32 v[78:79], v[78:79], v[82:83], v[82:83] op_sel:[0,0,1] op_sel_hi:[1,0,1]
    v_cvt_pk_bf16_f32 v32, v72, v73
    v_cvt_pk_bf16_f32 v33, v74, v75
    v_cvt_pk_bf16_f32 v34, v76, v77
    v_cvt_pk_bf16_f32 v35, v78, v79
    ds_write_b128 v36, v[32:35] offset:33536
    s_waitcnt lgkmcnt(0)
    s_cmp_ge_u32 s76, 4
    s_cbranch_scc1 L_g1
    s_branch L_g0
.p2align 12
L_g0:
L_pg0:
    s_cbranch_execz L_warmed
    s_add_u32 m0, s87, 24576
    s_xor_b32 s85, s100, 1
    s_mul_i32 s85, s85, 352256
    s_add_u32 s86, s91, s85
    s_add_u32 s86, s86, 1376
    buffer_load_dwordx4 v37, s[20:23], s86 offen offset:0 lds
    v_bfe_u32 v20, v1, 3, 2
    v_lshrrev_b32 v21, 5, v1
    v_lshl_add_u32 v20, v21, 3, v20
    s_lshl_b32 s82, s77, 4
    v_add_u32 v20, s82, v20
    v_mul_u32_u24 v18, 3072, v20
    buffer_load_dwordx4 v38, s[20:23], s86 offen offset:1024 lds
    v_lshlrev_b32 v21, 1, v2
    v_xor_b32 v21, v21, v1
    v_and_b32 v21, 7, v21
    v_lshl_add_u32 v18, v21, 4, v18
    s_lshl_b32 s93, s73, 7
    s_lshl_b32 s82, s79, 3
    v_lshrrev_b32 v20, 3, v1
    buffer_load_dwordx4 v39, s[20:23], s86 offen offset:2048 lds
    v_add_u32 v20, s82, v20
    v_lshrrev_b32 v21, 1, v20
    v_xor_b32 v21, v1, v21
    v_and_b32 v21, 7, v21
    v_lshlrev_b32 v21, 4, v21
    s_add_u32 m0, s87, 27648
    s_add_u32 s86, s86, 44032
    buffer_load_dwordx4 v37, s[20:23], s86 offen offset:0 lds
    v_lshl_add_u32 v4, v20, 13, v21
    v_add_u32 v5, 0xc00, v4
    v_add_u32 v6, 0x1f800, v4
    v_add_u32 v7, 0x20400, v4
    v_lshlrev_b32 v22, 4, v1
    buffer_load_dwordx4 v38, s[20:23], s86 offen offset:1024 lds
    v_add_u32 v23, 128, v22
    v_cmp_lt_u32 vcc, 23, v1
    s_nop 1
    v_cndmask_b32 v22, v22, v23, vcc
    v_add_u32 v23, 1024, v22
    v_add_u32 v24, 2048, v22
    v_add_u32 v25, 3072, v22
    buffer_load_dwordx4 v39, s[20:23], s86 offen offset:2048 lds
    s_cmp_eq_u32 s75, 1
    s_cselect_b32 s82, 0, 0x80000000
    s_cmp_eq_u32 s79, 0
    s_cselect_b32 s83, 0, s82
    v_or_b32 v8, s83, v24
    s_cmp_eq_u32 s80, 0
    s_cselect_b32 s82, 0, s82
    v_or_b32 v16, s82, v24
    v_lshrrev_b32 v20, 3, v1
    v_lshrrev_b32 v21, 4, v1
    v_lshlrev_b32 v21, 1, v21
    s_add_u32 m0, s87, 49152
    s_xor_b32 s85, s100, 2
    s_mul_i32 s85, s85, 352256
    s_add_u32 s86, s91, s85
    s_add_u32 s86, s86, 1376
    buffer_load_dwordx4 v37, s[20:23], s86 offen offset:0 lds
    v_xor_b32 v21, v21, v1
    v_and_b32 v21, 7, v21
    v_lshlrev_b32 v21, 4, v21
    v_lshl_add_u32 v9, v20, 10, v21
    v_and_b32 v20, 3, v3
    buffer_load_dwordx4 v38, s[20:23], s86 offen offset:1024 lds
    v_lshl_add_u32 v20, v2, 2, v20
    v_lshlrev_b32 v20, 4, v20
    v_lshrrev_b32 v21, 2, v3
    v_lshl_add_u32 v15, v21, 8, v20
    v_mov_b32 v17, 0xff
    buffer_load_dwordx4 v39, s[20:23], s86 offen offset:2048 lds
    s_lshl_b32 s95, s77, 12
    v_lshlrev_b32 v19, 7, v1
    s_and_b32 s82, s73, 3
    s_lshl_b32 s82, s82, 1
    s_add_u32 s82, s82, s97
    s_lshl_b32 s82, s82, 2
    s_add_u32 s82, s82, s77
    s_lshl_b32 s82, s82, 1
    s_add_u32 s82, s82, s81
    s_lshl_b32 s70, s82, 12
    s_xor_b32 s71, s70, 32768
    s_mul_i32 s82, s96, 2
    s_lshr_b32 s7, s82, 5
    s_add_u32 m0, s87, 52224
    s_add_u32 s86, s86, 44032
    buffer_load_dwordx4 v37, s[20:23], s86 offen offset:0 lds
    buffer_load_dwordx4 v38, s[20:23], s86 offen offset:1024 lds
    buffer_load_dwordx4 v39, s[20:23], s86 offen offset:2048 lds
    s_lshl_b32 s89, s72, 1
    s_add_u32 s89, s89, s79
    s_lshl_b32 s89, s89, 12
    s_add_u32 s89, s89, 0xa00000
    s_lshl_b32 s82, s73, 1
    s_add_u32 s82, s82, s80
    s_lshl_b32 s82, s82, 8
    s_add_u32 s92, s82, s89
    v_lshlrev_b32 v20, 2, v1
    s_setprio 2
    s_waitcnt vmcnt(6)
    s_barrier
    v_mov_b32 v26, 0
    ds_read_b64_tr_b16 v[104:105], v44 offset:0
    ds_read_b64_tr_b16 v[106:107], v44 offset:768
    ds_read_b64_tr_b16 v[108:109], v45 offset:0
    ds_read_b64_tr_b16 v[110:111], v45 offset:768
    ds_read_b64_tr_b16 v[112:113], v44 offset:64
    ds_read_b64_tr_b16 v[114:115], v44 offset:832
    v_xor_b32 v40, s101, v40
    ds_read_b128 v[96:99], v40 offset:0
    ds_read_b128 v[100:103], v40 offset:16384
    ds_read_b64_tr_b16 v[124:125], v46 offset:0
    ds_read_b64_tr_b16 v[126:127], v46 offset:768
    ds_read_b64_tr_b16 v[128:129], v47 offset:0
    ds_read_b64_tr_b16 v[130:131], v47 offset:768
    ds_read_b64_tr_b16 v[132:133], v46 offset:64
    ds_read_b64_tr_b16 v[134:135], v46 offset:832
    v_xor_b32 v41, s101, v41
    ds_read_b128 v[116:119], v41 offset:0
    ds_read_b128 v[120:123], v41 offset:16384
    s_waitcnt lgkmcnt(8)
    v_mfma_f32_16x16x32_bf16 v[28:31], v[96:99], v[104:107], 0
    ds_read_b64_tr_b16 v[144:145], v44 offset:12288
    ds_read_b64_tr_b16 v[146:147], v44 offset:13056
    v_mfma_f32_16x16x32_bf16 v[84:87], v[100:103], v[104:107], 0
    ds_read_b64_tr_b16 v[148:149], v45 offset:12288
    v_mfma_f32_16x16x32_bf16 v[32:35], v[96:99], v[108:111], 0
    ds_read_b64_tr_b16 v[150:151], v45 offset:13056
    ds_read_b64_tr_b16 v[152:153], v44 offset:12352
    v_mfma_f32_16x16x32_bf16 v[88:91], v[100:103], v[108:111], 0
    ds_read_b64_tr_b16 v[154:155], v44 offset:13120
    v_mfma_f32_16x16x32_bf16 v[80:83], v[96:99], v[112:115], 0
    v_xor_b32 v42, s101, v42
    ds_read_b128 v[136:139], v42 offset:0
    v_mfma_f32_16x16x32_bf16 v[92:95], v[100:103], v[112:115], 0
    ds_read_b128 v[140:143], v42 offset:16384
    s_waitcnt lgkmcnt(8)
    v_mfma_f32_16x16x32_bf16 v[28:31], v[116:119], v[124:127], v[28:31]
    ds_read_b64_tr_b16 v[104:105], v46 offset:12288
    ds_read_b64_tr_b16 v[106:107], v46 offset:13056
    v_mfma_f32_16x16x32_bf16 v[84:87], v[120:123], v[124:127], v[84:87]
    ds_read_b64_tr_b16 v[108:109], v47 offset:12288
    v_mfma_f32_16x16x32_bf16 v[32:35], v[116:119], v[128:131], v[32:35]
    ds_read_b64_tr_b16 v[110:111], v47 offset:13056
    ds_read_b64_tr_b16 v[112:113], v46 offset:12352
    v_mfma_f32_16x16x32_bf16 v[88:91], v[120:123], v[128:131], v[88:91]
    ds_read_b64_tr_b16 v[114:115], v46 offset:13120
    v_mfma_f32_16x16x32_bf16 v[80:83], v[116:119], v[132:135], v[80:83]
    v_xor_b32 v43, s101, v43
    ds_read_b128 v[96:99], v43 offset:0
    v_mfma_f32_16x16x32_bf16 v[92:95], v[120:123], v[132:135], v[92:95]
    ds_read_b128 v[100:103], v43 offset:16384
    s_waitcnt lgkmcnt(8)
    v_mfma_f32_16x16x32_bf16 v[28:31], v[136:139], v[144:147], v[28:31]
    ds_read_b64_tr_b16 v[124:125], v44 offset:24576
    ds_read_b64_tr_b16 v[126:127], v44 offset:25344
    v_mfma_f32_16x16x32_bf16 v[84:87], v[140:143], v[144:147], v[84:87]
    ds_read_b64_tr_b16 v[128:129], v45 offset:24576
    v_mfma_f32_16x16x32_bf16 v[32:35], v[136:139], v[148:151], v[32:35]
    ds_read_b64_tr_b16 v[130:131], v45 offset:25344
    ds_read_b64_tr_b16 v[132:133], v44 offset:24640
    v_mfma_f32_16x16x32_bf16 v[88:91], v[140:143], v[148:151], v[88:91]
    ds_read_b64_tr_b16 v[134:135], v44 offset:25408
    v_mfma_f32_16x16x32_bf16 v[80:83], v[136:139], v[152:155], v[80:83]
    v_xor_b32 v40, 256, v40
    ds_read_b128 v[116:119], v40 offset:0
    v_mfma_f32_16x16x32_bf16 v[92:95], v[140:143], v[152:155], v[92:95]
    ds_read_b128 v[120:123], v40 offset:16384
    s_waitcnt lgkmcnt(8)
    v_mfma_f32_16x16x32_bf16 v[28:31], v[96:99], v[104:107], v[28:31]
    ds_read_b64_tr_b16 v[144:145], v46 offset:24576
    ds_read_b64_tr_b16 v[146:147], v46 offset:25344
    v_mfma_f32_16x16x32_bf16 v[84:87], v[100:103], v[104:107], v[84:87]
    ds_read_b64_tr_b16 v[148:149], v47 offset:24576
    v_mfma_f32_16x16x32_bf16 v[32:35], v[96:99], v[108:111], v[32:35]
    ds_read_b64_tr_b16 v[150:151], v47 offset:25344
    ds_read_b64_tr_b16 v[152:153], v46 offset:24640
    v_mfma_f32_16x16x32_bf16 v[88:91], v[100:103], v[108:111], v[88:91]
    ds_read_b64_tr_b16 v[154:155], v46 offset:25408
    v_mfma_f32_16x16x32_bf16 v[80:83], v[96:99], v[112:115], v[80:83]
    v_xor_b32 v41, 256, v41
    ds_read_b128 v[136:139], v41 offset:0
    v_mfma_f32_16x16x32_bf16 v[92:95], v[100:103], v[112:115], v[92:95]
    ds_read_b128 v[140:143], v41 offset:16384
    s_waitcnt lgkmcnt(8)
    v_mfma_f32_16x16x32_bf16 v[28:31], v[116:119], v[124:127], v[28:31]
    ds_read_b64_tr_b16 v[104:105], v44 offset:36864
    ds_read_b64_tr_b16 v[106:107], v44 offset:37632
    v_mfma_f32_16x16x32_bf16 v[84:87], v[120:123], v[124:127], v[84:87]
    ds_read_b64_tr_b16 v[108:109], v45 offset:36864
    v_mfma_f32_16x16x32_bf16 v[32:35], v[116:119], v[128:131], v[32:35]
    ds_read_b64_tr_b16 v[110:111], v45 offset:37632
    ds_read_b64_tr_b16 v[112:113], v44 offset:36928
    v_mfma_f32_16x16x32_bf16 v[88:91], v[120:123], v[128:131], v[88:91]
    ds_read_b64_tr_b16 v[114:115], v44 offset:37696
    v_mfma_f32_16x16x32_bf16 v[80:83], v[116:119], v[132:135], v[80:83]
    v_xor_b32 v42, 256, v42
    ds_read_b128 v[96:99], v42 offset:0
    v_mfma_f32_16x16x32_bf16 v[92:95], v[120:123], v[132:135], v[92:95]
    ds_read_b128 v[100:103], v42 offset:16384
    s_waitcnt lgkmcnt(8)
    v_mfma_f32_16x16x32_bf16 v[28:31], v[136:139], v[144:147], v[28:31]
    ds_read_b64_tr_b16 v[124:125], v46 offset:36864
    ds_read_b64_tr_b16 v[126:127], v46 offset:37632
    v_mfma_f32_16x16x32_bf16 v[84:87], v[140:143], v[144:147], v[84:87]
    ds_read_b64_tr_b16 v[128:129], v47 offset:36864
    v_mfma_f32_16x16x32_bf16 v[32:35], v[136:139], v[148:151], v[32:35]
    ds_read_b64_tr_b16 v[130:131], v47 offset:37632
    ds_read_b64_tr_b16 v[132:133], v46 offset:36928
    v_mfma_f32_16x16x32_bf16 v[88:91], v[140:143], v[148:151], v[88:91]
    ds_read_b64_tr_b16 v[134:135], v46 offset:37696
    v_mfma_f32_16x16x32_bf16 v[80:83], v[136:139], v[152:155], v[80:83]
    v_xor_b32 v43, 256, v43
    ds_read_b128 v[116:119], v43 offset:0
    v_mfma_f32_16x16x32_bf16 v[92:95], v[140:143], v[152:155], v[92:95]
    ds_read_b128 v[120:123], v43 offset:16384
    s_waitcnt vmcnt(0)
    s_barrier
    s_waitcnt lgkmcnt(8)
    v_mfma_f32_16x16x32_bf16 v[28:31], v[96:99], v[104:107], v[28:31]
    ds_read_b64_tr_b16 v[144:145], v44 offset:49152
    ds_read_b64_tr_b16 v[146:147], v44 offset:49920
    v_mfma_f32_16x16x32_bf16 v[84:87], v[100:103], v[104:107], v[84:87]
    ds_read_b64_tr_b16 v[148:149], v45 offset:49152
    ds_read_b64_tr_b16 v[150:151], v45 offset:49920
    v_mfma_f32_16x16x32_bf16 v[32:35], v[96:99], v[108:111], v[32:35]
    ds_read_b64_tr_b16 v[152:153], v44 offset:49216
    v_mfma_f32_16x16x32_bf16 v[88:91], v[100:103], v[108:111], v[88:91]
    ds_read_b64_tr_b16 v[154:155], v44 offset:49984
    v_xor_b32 v40, 768, v40
    v_mfma_f32_16x16x32_bf16 v[80:83], v[96:99], v[112:115], v[80:83]
    ds_read_b128 v[136:139], v40 offset:0
    ds_read_b128 v[140:143], v40 offset:16384
    v_mfma_f32_16x16x32_bf16 v[92:95], v[100:103], v[112:115], v[92:95]
    buffer_load_dword v21, v26, s[40:43], 0 offen sc1
    s_waitcnt lgkmcnt(8)
    v_mfma_f32_16x16x32_bf16 v[28:31], v[116:119], v[124:127], v[28:31]
    ds_read_b64_tr_b16 v[104:105], v46 offset:49152
    ds_read_b64_tr_b16 v[106:107], v46 offset:49920
    v_mfma_f32_16x16x32_bf16 v[84:87], v[120:123], v[124:127], v[84:87]
    ds_read_b64_tr_b16 v[108:109], v47 offset:49152
    v_mfma_f32_16x16x32_bf16 v[32:35], v[116:119], v[128:131], v[32:35]
    ds_read_b64_tr_b16 v[110:111], v47 offset:49920
    ds_read_b64_tr_b16 v[112:113], v46 offset:49216
    v_mfma_f32_16x16x32_bf16 v[88:91], v[120:123], v[128:131], v[88:91]
    ds_read_b64_tr_b16 v[114:115], v46 offset:49984
    v_mfma_f32_16x16x32_bf16 v[80:83], v[116:119], v[132:135], v[80:83]
    v_xor_b32 v41, 768, v41
    ds_read_b128 v[96:99], v41 offset:0
    v_mfma_f32_16x16x32_bf16 v[92:95], v[120:123], v[132:135], v[92:95]
    ds_read_b128 v[100:103], v41 offset:16384
    s_waitcnt lgkmcnt(8)
    v_mfma_f32_16x16x32_bf16 v[28:31], v[136:139], v[144:147], v[28:31]
    ds_read_b64_tr_b16 v[124:125], v44 offset:61440
    ds_read_b64_tr_b16 v[126:127], v44 offset:62208
    v_mfma_f32_16x16x32_bf16 v[84:87], v[140:143], v[144:147], v[84:87]
    ds_read_b64_tr_b16 v[128:129], v45 offset:61440
    v_mfma_f32_16x16x32_bf16 v[32:35], v[136:139], v[148:151], v[32:35]
    ds_read_b64_tr_b16 v[130:131], v45 offset:62208
    ds_read_b64_tr_b16 v[132:133], v44 offset:61504
    v_mfma_f32_16x16x32_bf16 v[88:91], v[140:143], v[148:151], v[88:91]
    ds_read_b64_tr_b16 v[134:135], v44 offset:62272
    v_mfma_f32_16x16x32_bf16 v[80:83], v[136:139], v[152:155], v[80:83]
    v_xor_b32 v42, 768, v42
    ds_read_b128 v[116:119], v42 offset:0
    v_mfma_f32_16x16x32_bf16 v[92:95], v[140:143], v[152:155], v[92:95]
    ds_read_b128 v[120:123], v42 offset:16384
    s_waitcnt lgkmcnt(8)
    v_mfma_f32_16x16x32_bf16 v[28:31], v[96:99], v[104:107], v[28:31]
    ds_read_b64_tr_b16 v[144:145], v46 offset:61440
    ds_read_b64_tr_b16 v[146:147], v46 offset:62208
    v_mfma_f32_16x16x32_bf16 v[84:87], v[100:103], v[104:107], v[84:87]
    ds_read_b64_tr_b16 v[148:149], v47 offset:61440
    v_mfma_f32_16x16x32_bf16 v[32:35], v[96:99], v[108:111], v[32:35]
    ds_read_b64_tr_b16 v[150:151], v47 offset:62208
    ds_read_b64_tr_b16 v[152:153], v46 offset:61504
    v_mfma_f32_16x16x32_bf16 v[88:91], v[100:103], v[108:111], v[88:91]
    ds_read_b64_tr_b16 v[154:155], v46 offset:62272
    v_mfma_f32_16x16x32_bf16 v[80:83], v[96:99], v[112:115], v[80:83]
    v_xor_b32 v43, 768, v43
    ds_read_b128 v[136:139], v43 offset:0
    v_mfma_f32_16x16x32_bf16 v[92:95], v[100:103], v[112:115], v[92:95]
    ds_read_b128 v[140:143], v43 offset:16384
    s_barrier
    s_waitcnt lgkmcnt(8)
    v_mfma_f32_16x16x32_bf16 v[28:31], v[116:119], v[124:127], v[28:31]
    v_add_u32 v44, 24576, v44
    v_add_u32 v45, 24576, v45
    v_add_u32 v46, 24576, v46
    v_mfma_f32_16x16x32_bf16 v[84:87], v[120:123], v[124:127], v[84:87]
    v_add_u32 v47, 24576, v47
    ds_read_b64_tr_b16 v[104:105], v44 offset:49152
    v_mfma_f32_16x16x32_bf16 v[32:35], v[116:119], v[128:131], v[32:35]
    ds_read_b64_tr_b16 v[106:107], v44 offset:49920
    ds_read_b64_tr_b16 v[108:109], v45 offset:49152
    v_mfma_f32_16x16x32_bf16 v[88:91], v[120:123], v[128:131], v[88:91]
    ds_read_b64_tr_b16 v[110:111], v45 offset:49920
    ds_read_b64_tr_b16 v[112:113], v44 offset:49216
    v_mfma_f32_16x16x32_bf16 v[80:83], v[116:119], v[132:135], v[80:83]
    ds_read_b64_tr_b16 v[114:115], v44 offset:49984
    v_xor_b32 v40, 256, v40
    v_mfma_f32_16x16x32_bf16 v[92:95], v[120:123], v[132:135], v[92:95]
    ds_read_b128 v[96:99], v40 offset:0
    ds_read_b128 v[100:103], v40 offset:16384
    s_waitcnt lgkmcnt(8)
    v_mfma_f32_16x16x32_bf16 v[28:31], v[136:139], v[144:147], v[28:31]
    ds_read_b64_tr_b16 v[124:125], v46 offset:49152
    ds_read_b64_tr_b16 v[126:127], v46 offset:49920
    v_mfma_f32_16x16x32_bf16 v[84:87], v[140:143], v[144:147], v[84:87]
    ds_read_b64_tr_b16 v[128:129], v47 offset:49152
    v_mfma_f32_16x16x32_bf16 v[32:35], v[136:139], v[148:151], v[32:35]
    ds_read_b64_tr_b16 v[130:131], v47 offset:49920
    ds_read_b64_tr_b16 v[132:133], v46 offset:49216
    v_mfma_f32_16x16x32_bf16 v[88:91], v[140:143], v[148:151], v[88:91]
    ds_read_b64_tr_b16 v[134:135], v46 offset:49984
    v_mfma_f32_16x16x32_bf16 v[80:83], v[136:139], v[152:155], v[80:83]
    v_xor_b32 v41, 256, v41
    ds_read_b128 v[116:119], v41 offset:0
    v_mfma_f32_16x16x32_bf16 v[92:95], v[140:143], v[152:155], v[92:95]
    ds_read_b128 v[120:123], v41 offset:16384
    s_waitcnt lgkmcnt(8)
    v_mfma_f32_16x16x32_bf16 v[28:31], v[96:99], v[104:107], v[28:31]
    ds_read_b64_tr_b16 v[144:145], v44 offset:61440
    ds_read_b64_tr_b16 v[146:147], v44 offset:62208
    v_mfma_f32_16x16x32_bf16 v[84:87], v[100:103], v[104:107], v[84:87]
    ds_read_b64_tr_b16 v[148:149], v45 offset:61440
    v_mfma_f32_16x16x32_bf16 v[32:35], v[96:99], v[108:111], v[32:35]
    ds_read_b64_tr_b16 v[150:151], v45 offset:62208
    ds_read_b64_tr_b16 v[152:153], v44 offset:61504
    v_mfma_f32_16x16x32_bf16 v[88:91], v[100:103], v[108:111], v[88:91]
    ds_read_b64_tr_b16 v[154:155], v44 offset:62272
    v_mfma_f32_16x16x32_bf16 v[80:83], v[96:99], v[112:115], v[80:83]
    v_xor_b32 v42, 256, v42
    ds_read_b128 v[136:139], v42 offset:0
    v_mfma_f32_16x16x32_bf16 v[92:95], v[100:103], v[112:115], v[92:95]
    ds_read_b128 v[140:143], v42 offset:16384
    s_waitcnt lgkmcnt(8)
    v_mfma_f32_16x16x32_bf16 v[28:31], v[116:119], v[124:127], v[28:31]
    ds_read_b64_tr_b16 v[104:105], v46 offset:61440
    ds_read_b64_tr_b16 v[106:107], v46 offset:62208
    v_mfma_f32_16x16x32_bf16 v[84:87], v[120:123], v[124:127], v[84:87]
    ds_read_b64_tr_b16 v[108:109], v47 offset:61440
    v_mfma_f32_16x16x32_bf16 v[32:35], v[116:119], v[128:131], v[32:35]
    ds_read_b64_tr_b16 v[110:111], v47 offset:62208
    ds_read_b64_tr_b16 v[112:113], v46 offset:61504
    v_mfma_f32_16x16x32_bf16 v[88:91], v[120:123], v[128:131], v[88:91]
    ds_read_b64_tr_b16 v[114:115], v46 offset:62272
    v_mfma_f32_16x16x32_bf16 v[80:83], v[116:119], v[132:135], v[80:83]
    v_xor_b32 v43, 256, v43
    ds_read_b128 v[96:99], v43 offset:0
    v_mfma_f32_16x16x32_bf16 v[92:95], v[120:123], v[132:135], v[92:95]
    ds_read_b128 v[100:103], v43 offset:16384
    s_waitcnt lgkmcnt(8)
    v_mfma_f32_16x16x32_bf16 v[28:31], v[136:139], v[144:147], v[28:31]
    v_mfma_f32_16x16x32_bf16 v[84:87], v[140:143], v[144:147], v[84:87]
    v_mfma_f32_16x16x32_bf16 v[32:35], v[136:139], v[148:151], v[32:35]
    v_mfma_f32_16x16x32_bf16 v[88:91], v[140:143], v[148:151], v[88:91]
    v_mfma_f32_16x16x32_bf16 v[80:83], v[136:139], v[152:155], v[80:83]
    v_mfma_f32_16x16x32_bf16 v[92:95], v[140:143], v[152:155], v[92:95]
    s_waitcnt lgkmcnt(0)
    s_barrier
    v_mfma_f32_16x16x32_bf16 v[28:31], v[96:99], v[104:107], v[28:31]
    v_mfma_f32_16x16x32_bf16 v[84:87], v[100:103], v[104:107], v[84:87]
    v_mfma_f32_16x16x32_bf16 v[32:35], v[96:99], v[108:111], v[32:35]
    v_mfma_f32_16x16x32_bf16 v[88:91], v[100:103], v[108:111], v[88:91]
    v_mfma_f32_16x16x32_bf16 v[80:83], v[96:99], v[112:115], v[80:83]
    v_mfma_f32_16x16x32_bf16 v[92:95], v[100:103], v[112:115], v[92:95]
    v_mov_b32 v26, 0xc0135761
    v_mov_b32 v27, 0xbdd2d3e8
    s_nop 0
    v_pk_mul_f32 v[40:41], v[28:29], v[28:29]
    v_pk_mul_f32 v[42:43], v[30:31], v[30:31]
    v_pk_mul_f32 v[44:45], v[32:33], v[32:33]
    v_pk_mul_f32 v[46:47], v[34:35], v[34:35]
    v_pk_fma_f32 v[40:41], v[40:41], v[26:27], v[26:27] op_sel:[0,1,0] op_sel_hi:[1,1,0]
    v_pk_fma_f32 v[42:43], v[42:43], v[26:27], v[26:27] op_sel:[0,1,0] op_sel_hi:[1,1,0]
    v_pk_fma_f32 v[44:45], v[44:45], v[26:27], v[26:27] op_sel:[0,1,0] op_sel_hi:[1,1,0]
    v_pk_fma_f32 v[46:47], v[46:47], v[26:27], v[26:27] op_sel:[0,1,0] op_sel_hi:[1,1,0]
    v_pk_mul_f32 v[40:41], v[40:41], v[28:29]
    v_pk_mul_f32 v[42:43], v[42:43], v[30:31]
    v_pk_mul_f32 v[44:45], v[44:45], v[32:33]
    v_pk_mul_f32 v[46:47], v[46:47], v[34:35]
    v_exp_f32 v40, v40
    v_exp_f32 v41, v41
    v_exp_f32 v42, v42
    v_exp_f32 v43, v43
    v_exp_f32 v44, v44
    v_exp_f32 v45, v45
    v_exp_f32 v46, v46
    v_exp_f32 v47, v47
    v_pk_add_f32 v[40:41], v[40:41], 1.0 op_sel_hi:[1,0]
    v_pk_add_f32 v[42:43], v[42:43], 1.0 op_sel_hi:[1,0]
    v_pk_add_f32 v[44:45], v[44:45], 1.0 op_sel_hi:[1,0]
    v_pk_add_f32 v[46:47], v[46:47], 1.0 op_sel_hi:[1,0]
    v_rcp_f32 v40, v40
    v_rcp_f32 v41, v41
    v_rcp_f32 v42, v42
    v_rcp_f32 v43, v43
    v_rcp_f32 v44, v44
    v_rcp_f32 v45, v45
    v_rcp_f32 v46, v46
    v_rcp_f32 v47, v47
    v_pk_mul_f32 v[28:29], v[40:41], v[28:29]
    v_pk_mul_f32 v[30:31], v[42:43], v[30:31]
    v_pk_mul_f32 v[32:33], v[44:45], v[32:33]
    v_pk_mul_f32 v[34:35], v[46:47], v[34:35]
    v_pk_mul_f32 v[40:41], v[80:81], v[80:81]
    v_pk_mul_f32 v[42:43], v[82:83], v[82:83]
    v_pk_mul_f32 v[44:45], v[84:85], v[84:85]
    v_pk_mul_f32 v[46:47], v[86:87], v[86:87]
    v_pk_fma_f32 v[40:41], v[40:41], v[26:27], v[26:27] op_sel:[0,1,0] op_sel_hi:[1,1,0]
    v_pk_fma_f32 v[42:43], v[42:43], v[26:27], v[26:27] op_sel:[0,1,0] op_sel_hi:[1,1,0]
    v_pk_fma_f32 v[44:45], v[44:45], v[26:27], v[26:27] op_sel:[0,1,0] op_sel_hi:[1,1,0]
    v_pk_fma_f32 v[46:47], v[46:47], v[26:27], v[26:27] op_sel:[0,1,0] op_sel_hi:[1,1,0]
    v_pk_mul_f32 v[40:41], v[40:41], v[80:81]
    v_pk_mul_f32 v[42:43], v[42:43], v[82:83]
    v_pk_mul_f32 v[44:45], v[44:45], v[84:85]
    v_pk_mul_f32 v[46:47], v[46:47], v[86:87]
    v_exp_f32 v40, v40
    v_exp_f32 v41, v41
    v_exp_f32 v42, v42
    v_exp_f32 v43, v43
    v_exp_f32 v44, v44
    v_exp_f32 v45, v45
    v_exp_f32 v46, v46
    v_exp_f32 v47, v47
    v_pk_add_f32 v[40:41], v[40:41], 1.0 op_sel_hi:[1,0]
    v_pk_add_f32 v[42:43], v[42:43], 1.0 op_sel_hi:[1,0]
    v_pk_add_f32 v[44:45], v[44:45], 1.0 op_sel_hi:[1,0]
    v_pk_add_f32 v[46:47], v[46:47], 1.0 op_sel_hi:[1,0]
    v_rcp_f32 v40, v40
    v_rcp_f32 v41, v41
    v_rcp_f32 v42, v42
    v_rcp_f32 v43, v43
    v_rcp_f32 v44, v44
    v_rcp_f32 v45, v45
    v_rcp_f32 v46, v46
    v_rcp_f32 v47, v47
    v_pk_mul_f32 v[80:81], v[40:41], v[80:81]
    v_pk_mul_f32 v[82:83], v[42:43], v[82:83]
    v_pk_mul_f32 v[84:85], v[44:45], v[84:85]
    v_pk_mul_f32 v[86:87], v[46:47], v[86:87]
    v_pk_mul_f32 v[40:41], v[88:89], v[88:89]
    v_pk_mul_f32 v[42:43], v[90:91], v[90:91]
    v_pk_mul_f32 v[44:45], v[92:93], v[92:93]
    v_pk_mul_f32 v[46:47], v[94:95], v[94:95]
    v_pk_fma_f32 v[40:41], v[40:41], v[26:27], v[26:27] op_sel:[0,1,0] op_sel_hi:[1,1,0]
    v_pk_fma_f32 v[42:43], v[42:43], v[26:27], v[26:27] op_sel:[0,1,0] op_sel_hi:[1,1,0]
    v_pk_fma_f32 v[44:45], v[44:45], v[26:27], v[26:27] op_sel:[0,1,0] op_sel_hi:[1,1,0]
    v_pk_fma_f32 v[46:47], v[46:47], v[26:27], v[26:27] op_sel:[0,1,0] op_sel_hi:[1,1,0]
    v_pk_mul_f32 v[40:41], v[40:41], v[88:89]
    v_pk_mul_f32 v[42:43], v[42:43], v[90:91]
    v_pk_mul_f32 v[44:45], v[44:45], v[92:93]
    v_pk_mul_f32 v[46:47], v[46:47], v[94:95]
    v_exp_f32 v40, v40
    v_exp_f32 v41, v41
    v_exp_f32 v42, v42
    v_exp_f32 v43, v43
    v_exp_f32 v44, v44
    v_exp_f32 v45, v45
    v_exp_f32 v46, v46
    v_exp_f32 v47, v47
    v_pk_add_f32 v[40:41], v[40:41], 1.0 op_sel_hi:[1,0]
    v_pk_add_f32 v[42:43], v[42:43], 1.0 op_sel_hi:[1,0]
    v_pk_add_f32 v[44:45], v[44:45], 1.0 op_sel_hi:[1,0]
    v_pk_add_f32 v[46:47], v[46:47], 1.0 op_sel_hi:[1,0]
    v_rcp_f32 v40, v40
    v_rcp_f32 v41, v41
    v_rcp_f32 v42, v42
    v_rcp_f32 v43, v43
    v_rcp_f32 v44, v44
    v_rcp_f32 v45, v45
    v_rcp_f32 v46, v46
    v_rcp_f32 v47, v47
    v_pk_mul_f32 v[88:89], v[40:41], v[88:89]
    v_pk_mul_f32 v[90:91], v[42:43], v[90:91]
    v_pk_mul_f32 v[92:93], v[44:45], v[92:93]
    v_pk_mul_f32 v[94:95], v[46:47], v[94:95]
    s_mov_b32 s88, 32768
    s_waitcnt vmcnt(0)
    v_readfirstlane_b32 s78, v21
    s_nop 0
    s_cmp_lg_u32 s78, 0
    s_cbranch_scc1 L_n0_ok
    v_mov_b32 v26, 0
L_n0_spin:
    s_sleep 1
    buffer_load_dword v21, v26, s[40:43], 0 offen sc1
    s_waitcnt vmcnt(0)
    v_readfirstlane_b32 s78, v21
    s_sub_u32 s88, s88, 1
    s_cbranch_scc1 L_n0_ok
    s_cmp_eq_u32 s78, 0
    s_cbranch_scc1 L_n0_spin
L_n0_ok:
    s_bfe_u32 s52, s78, 0x80000
    s_bfe_u32 s53, s78, 0x80008
    s_bfe_u32 s54, s78, 0x80010
    s_bfe_u32 s55, s78, 0x80018
    v_pk_add_f32 v[48:49], v[28:29], v[32:33]
    v_pk_mul_f32 v[52:53], v[28:29], v[28:29]
    v_pk_add_f32 v[48:49], v[48:49], v[80:81]
    v_pk_fma_f32 v[52:53], v[32:33], v[32:33], v[52:53]
    v_pk_fma_f32 v[52:53], v[80:81], v[80:81], v[52:53]
    v_pk_add_f32 v[50:51], v[30:31], v[34:35]
    v_pk_mul_f32 v[54:55], v[30:31], v[30:31]
    v_pk_add_f32 v[50:51], v[50:51], v[82:83]
    v_pk_fma_f32 v[54:55], v[34:35], v[34:35], v[54:55]
    v_pk_fma_f32 v[54:55], v[82:83], v[82:83], v[54:55]
    v_pk_add_f32 v[56:57], v[84:85], v[88:89]
    v_pk_mul_f32 v[60:61], v[84:85], v[84:85]
    v_pk_add_f32 v[56:57], v[56:57], v[92:93]
    v_pk_fma_f32 v[60:61], v[88:89], v[88:89], v[60:61]
    v_pk_fma_f32 v[60:61], v[92:93], v[92:93], v[60:61]
    v_pk_add_f32 v[58:59], v[86:87], v[90:91]
    v_pk_mul_f32 v[62:63], v[86:87], v[86:87]
    v_pk_add_f32 v[58:59], v[58:59], v[94:95]
    v_pk_fma_f32 v[62:63], v[90:91], v[90:91], v[62:63]
    v_pk_fma_f32 v[62:63], v[94:95], v[94:95], v[62:63]
    v_add_f32_dpp v48, v48, v48 row_ror:8 row_mask:0xf bank_mask:0x3
    v_add_f32_dpp v49, v49, v49 row_ror:8 row_mask:0xf bank_mask:0x3
    v_add_f32_dpp v52, v52, v52 row_ror:8 row_mask:0xf bank_mask:0x3
    v_add_f32_dpp v53, v53, v53 row_ror:8 row_mask:0xf bank_mask:0x3
    v_add_f32_dpp v56, v56, v56 row_ror:8 row_mask:0xf bank_mask:0x3
    v_add_f32_dpp v57, v57, v57 row_ror:8 row_mask:0xf bank_mask:0x3
    v_add_f32_dpp v60, v60, v60 row_ror:8 row_mask:0xf bank_mask:0x3
    v_add_f32_dpp v61, v61, v61 row_ror:8 row_mask:0xf bank_mask:0x3
    v_add_f32_dpp v48, v50, v50 row_ror:8 row_mask:0xf bank_mask:0xc
    v_add_f32_dpp v49, v51, v51 row_ror:8 row_mask:0xf bank_mask:0xc
    v_add_f32_dpp v52, v54, v54 row_ror:8 row_mask:0xf bank_mask:0xc
    v_add_f32_dpp v53, v55, v55 row_ror:8 row_mask:0xf bank_mask:0xc
    v_add_f32_dpp v56, v58, v58 row_ror:8 row_mask:0xf bank_mask:0xc
    v_add_f32_dpp v57, v59, v59 row_ror:8 row_mask:0xf bank_mask:0xc
    v_add_f32_dpp v60, v62, v62 row_ror:8 row_mask:0xf bank_mask:0xc
    v_add_f32_dpp v61, v63, v63 row_ror:8 row_mask:0xf bank_mask:0xc
    v_add_f32_dpp v48, v48, v48 row_half_mirror row_mask:0xf bank_mask:0x5
    v_add_f32_dpp v52, v52, v52 row_half_mirror row_mask:0xf bank_mask:0x5
    v_add_f32_dpp v56, v56, v56 row_half_mirror row_mask:0xf bank_mask:0x5
    v_add_f32_dpp v60, v60, v60 row_half_mirror row_mask:0xf bank_mask:0x5
    v_add_f32_dpp v48, v49, v49 row_half_mirror row_mask:0xf bank_mask:0xa
    v_add_f32_dpp v52, v53, v53 row_half_mirror row_mask:0xf bank_mask:0xa
    v_add_f32_dpp v56, v57, v57 row_half_mirror row_mask:0xf bank_mask:0xa
    v_add_f32_dpp v60, v61, v61 row_half_mirror row_mask:0xf bank_mask:0xa
    v_add_f32_dpp v48, v48, v48 quad_perm:[1,0,3,2] row_mask:0xf bank_mask:0xf
    v_add_f32_dpp v52, v52, v52 quad_perm:[1,0,3,2] row_mask:0xf bank_mask:0xf
    v_add_f32_dpp v56, v56, v56 quad_perm:[1,0,3,2] row_mask:0xf bank_mask:0xf
    v_add_f32_dpp v60, v60, v60 quad_perm:[1,0,3,2] row_mask:0xf bank_mask:0xf
    v_add_f32_dpp v48, v48, v48 quad_perm:[2,3,0,1] row_mask:0xf bank_mask:0xf
    v_add_f32_dpp v52, v52, v52 quad_perm:[2,3,0,1] row_mask:0xf bank_mask:0xf
    v_add_f32_dpp v56, v56, v56 quad_perm:[2,3,0,1] row_mask:0xf bank_mask:0xf
    v_add_f32_dpp v60, v60, v60 quad_perm:[2,3,0,1] row_mask:0xf bank_mask:0xf
    v_bfi_b32 v64, v17, s52, v48
    v_bfi_b32 v65, v17, s53, v52
    v_bfi_b32 v66, v17, s54, v56
    v_bfi_b32 v67, v17, s55, v60
    s_mov_b32 exec_lo, 0x11111111
    s_mov_b32 exec_hi, 0x11111111
    buffer_store_dwordx4 v[64:67], v20, s[44:47], s92 offen sc1
    s_mov_b64 exec, -1
    s_setprio 0
    v_mov_b32 v14, 73728
    v_mov_b32 v10, s78
    ds_write_b32 v14, v10
    s_waitcnt lgkmcnt(0)
    s_cmp_eq_u32 s7, 1
    s_cbranch_scc1 L_var1
    s_barrier
    s_add_u32 m0, s87, 49152
    s_xor_b32 s85, s100, 2
    s_mul_i32 s85, s85, 352256
    s_add_u32 s86, s91, s85
    buffer_load_dwordx4 v37, s[20:23], s86 offen offset:0 lds
    buffer_load_dwordx4 v38, s[20:23], s86 offen offset:1024 lds
    buffer_load_dwordx4 v39, s[20:23], s86 offen offset:2048 lds
    s_add_u32 m0, s87, 52224
    s_add_u32 s86, s86, 44032
    buffer_load_dwordx4 v37, s[20:23], s86 offen offset:0 lds
    buffer_load_dwordx4 v38, s[20:23], s86 offen offset:1024 lds
    buffer_load_dwordx4 v39, s[20:23], s86 offen offset:2048 lds
    s_barrier
    s_add_u32 m0, s87, 0
    s_xor_b32 s85, s100, 3
    s_mul_i32 s85, s85, 352256
    s_add_u32 s86, s91, s85
    buffer_load_dwordx4 v37, s[20:23], s86 offen offset:0 lds
    buffer_load_dwordx4 v38, s[20:23], s86 offen offset:1024 lds
    buffer_load_dwordx4 v39, s[20:23], s86 offen offset:2048 lds
    s_add_u32 m0, s87, 3072
    s_add_u32 s86, s86, 44032
    buffer_load_dwordx4 v37, s[20:23], s86 offen offset:0 lds
    buffer_load_dwordx4 v38, s[20:23], s86 offen offset:1024 lds
    buffer_load_dwordx4 v39, s[20:23], s86 offen offset:2048 lds
    s_xor_b32 s91, s72, s80
    s_lshl_b32 s91, s91, 18
L_pg1:
    s_cbranch_execz L_warmed
    s_and_b32 s82, s72, 1
    s_lshl_b32 s82, s82, 11
    s_add_u32 s91, s91, s82
    s_waitcnt vmcnt(6)
    s_barrier
    s_add_u32 m0, s87, 24576
    s_add_u32 s86, s93, 0
    buffer_load_dwordx4 v18, s[12:15], s86 offen offset:0 lds
    buffer_load_dwordx4 v18, s[12:15], s86 offen offset:1024 lds
    buffer_load_dwordx4 v18, s[12:15], s86 offen offset:2048 lds
    s_add_u32 m0, s87, 27648
    s_add_u32 s86, s93, 12288
    buffer_load_dwordx4 v18, s[12:15], s86 offen offset:0 lds
    buffer_load_dwordx4 v18, s[12:15], s86 offen offset:1024 lds
    buffer_load_dwordx4 v18, s[12:15], s86 offen offset:2048 lds
    s_waitcnt vmcnt(6)
    s_barrier
    s_add_u32 m0, s87, 49152
    s_add_u32 s86, s93, 196608
    buffer_load_dwordx4 v18, s[12:15], s86 offen offset:0 lds
    buffer_load_dwordx4 v18, s[12:15], s86 offen offset:1024 lds
    buffer_load_dwordx4 v18, s[12:15], s86 offen offset:2048 lds
    s_add_u32 m0, s87, 52224
    s_add_u32 s86, s93, 208896
    buffer_load_dwordx4 v18, s[12:15], s86 offen offset:0 lds
    buffer_load_dwordx4 v18, s[12:15], s86 offen offset:1024 lds
    buffer_load_dwordx4 v18, s[12:15], s86 offen offset:2048 lds
    buffer_load_dwordx4 v[48:51], v15, s[44:47], s89 offen offset:0 sc1
    buffer_load_dwordx4 v[52:55], v15, s[44:47], s89 offen offset:1024 sc1
    buffer_load_dwordx4 v[56:59], v15, s[44:47], s89 offen offset:2048 sc1
    buffer_load_dwordx4 v[60:63], v15, s[44:47], s89 offen offset:3072 sc1
    s_waitcnt vmcnt(10)
    s_barrier
    buffer_load_dword v255, v19, s[24:27], s70 offen
    s_waitcnt vmcnt(1)
    v_xor_b32 v48, s52, v48
    v_xor_b32 v49, s53, v49
    v_xor_b32 v50, s54, v50
    v_xor_b32 v51, s55, v51
    v_or_b32 v14, v48, v49
    v_or3_b32 v14, v14, v50, v51
    v_xor_b32 v52, s52, v52
    v_xor_b32 v53, s53, v53
    v_xor_b32 v54, s54, v54
    v_xor_b32 v55, s55, v55
    v_or3_b32 v14, v14, v52, v53
    v_or3_b32 v14, v14, v54, v55
    v_xor_b32 v56, s52, v56
    v_xor_b32 v57, s53, v57
    v_xor_b32 v58, s54, v58
    v_xor_b32 v59, s55, v59
    v_or3_b32 v14, v14, v56, v57
    v_or3_b32 v14, v14, v58, v59
    v_xor_b32 v60, s52, v60
    v_xor_b32 v61, s53, v61
    v_xor_b32 v62, s54, v62
    v_xor_b32 v63, s55, v63
    v_or3_b32 v14, v14, v60, v61
    v_or3_b32 v14, v14, v62, v63
    v_and_b32 v14, v14, v17
    v_cmp_ne_u32 vcc, 0, v14
    s_cbranch_vccz L_gok_0
    s_mov_b32 s88, 32768
L_gchk_0:
    buffer_load_dwordx4 v[48:51], v15, s[44:47], s89 offen offset:0 sc1
    buffer_load_dwordx4 v[52:55], v15, s[44:47], s89 offen offset:1024 sc1
    buffer_load_dwordx4 v[56:59], v15, s[44:47], s89 offen offset:2048 sc1
    buffer_load_dwordx4 v[60:63], v15, s[44:47], s89 offen offset:3072 sc1
    s_waitcnt vmcnt(0)
    v_xor_b32 v48, s52, v48
    v_xor_b32 v49, s53, v49
    v_xor_b32 v50, s54, v50
    v_xor_b32 v51, s55, v51
    v_or_b32 v14, v48, v49
    v_or3_b32 v14, v14, v50, v51
    v_xor_b32 v52, s52, v52
    v_xor_b32 v53, s53, v53
    v_xor_b32 v54, s54, v54
    v_xor_b32 v55, s55, v55
    v_or3_b32 v14, v14, v52, v53
    v_or3_b32 v14, v14, v54, v55
    v_xor_b32 v56, s52, v56
    v_xor_b32 v57, s53, v57
    v_xor_b32 v58, s54, v58
    v_xor_b32 v59, s55, v59
    v_or3_b32 v14, v14, v56, v57
    v_or3_b32 v14, v14, v58, v59
    v_xor_b32 v60, s52, v60
    v_xor_b32 v61, s53, v61
    v_xor_b32 v62, s54, v62
    v_xor_b32 v63, s55, v63
    v_or3_b32 v14, v14, v60, v61
    v_or3_b32 v14, v14, v62, v63
    v_and_b32 v14, v14, v17
    v_cmp_ne_u32 vcc, 0, v14
    s_cbranch_vccz L_gok_0
    s_sub_u32 s88, s88, 1
    s_cbranch_scc0 L_gchk_0
L_gok_0:
    v_add_f32 v48, v48, v56
    v_add_f32 v49, v49, v57
    v_add_f32 v50, v50, v58
    v_add_f32 v51, v51, v59
    v_add_f32 v52, v52, v60
    v_add_f32 v53, v53, v61
    v_add_f32 v54, v54, v62
    v_add_f32 v55, v55, v63
    v_add_f32 v48, v48, v52
    v_add_f32 v49, v49, v53
    v_add_f32 v50, v50, v54
    v_add_f32 v51, v51, v55
    v_add_f32_dpp v48, v48, v48 row_ror:4 row_mask:0xf bank_mask:0xf
    v_add_f32_dpp v49, v49, v49 row_ror:4 row_mask:0xf bank_mask:0xf
    v_add_f32_dpp v50, v50, v50 row_ror:4 row_mask:0xf bank_mask:0xf
    v_add_f32_dpp v51, v51, v51 row_ror:4 row_mask:0xf bank_mask:0xf
    v_add_f32_dpp v48, v48, v48 row_ror:8 row_mask:0xf bank_mask:0xf
    v_add_f32_dpp v49, v49, v49 row_ror:8 row_mask:0xf bank_mask:0xf
    v_add_f32_dpp v50, v50, v50 row_ror:8 row_mask:0xf bank_mask:0xf
    v_add_f32_dpp v51, v51, v51 row_ror:8 row_mask:0xf bank_mask:0xf
    v_mul_f32 v48, 0x3abe82fa, v48
    v_mul_f32 v49, 0x3abe82fa, v49
    v_mul_f32 v50, 0x3abe82fa, v50
    v_mul_f32 v51, 0x3abe82fa, v51
    v_fma_f32 v49, -v48, v48, v49
    v_fma_f32 v51, -v50, v50, v51
    v_max_f32 v49, 0, v49
    v_max_f32 v51, 0, v51
    v_add_f32 v49, 0x3727c5ac, v49
    v_add_f32 v51, 0x3727c5ac, v51
    v_rsq_f32 v10, v49
    v_rsq_f32 v11, v51
    v_mul_f32 v12, -v48, v10
    v_mul_f32 v13, -v50, v11
    v_mov_b32_dpp v64, v10 row_newbcast:0 row_mask:0xf bank_mask:0xf
    v_mov_b32_dpp v65, v11 row_newbcast:0 row_mask:0xf bank_mask:0xf
    v_mov_b32_dpp v66, v10 row_newbcast:1 row_mask:0xf bank_mask:0xf
    v_mov_b32_dpp v67, v11 row_newbcast:1 row_mask:0xf bank_mask:0xf
    v_mov_b32_dpp v68, v10 row_newbcast:2 row_mask:0xf bank_mask:0xf
    v_mov_b32_dpp v69, v11 row_newbcast:2 row_mask:0xf bank_mask:0xf
    v_mov_b32_dpp v70, v10 row_newbcast:3 row_mask:0xf bank_mask:0xf
    v_mov_b32_dpp v71, v11 row_newbcast:3 row_mask:0xf bank_mask:0xf
    v_mov_b32_dpp v72, v12 row_newbcast:0 row_mask:0xf bank_mask:0xf
    v_mov_b32_dpp v73, v13 row_newbcast:0 row_mask:0xf bank_mask:0xf
    v_mov_b32_dpp v74, v12 row_newbcast:1 row_mask:0xf bank_mask:0xf
    v_mov_b32_dpp v75, v13 row_newbcast:1 row_mask:0xf bank_mask:0xf
    v_mov_b32_dpp v76, v12 row_newbcast:2 row_mask:0xf bank_mask:0xf
    v_mov_b32_dpp v77, v13 row_newbcast:2 row_mask:0xf bank_mask:0xf
    v_mov_b32_dpp v78, v12 row_newbcast:3 row_mask:0xf bank_mask:0xf
    v_mov_b32_dpp v79, v13 row_newbcast:3 row_mask:0xf bank_mask:0xf
    s_barrier
    v_fma_f32 v28, v28, v64, v72
    v_fma_f32 v29, v29, v66, v74
    v_fma_f32 v30, v30, v68, v76
    v_fma_f32 v31, v31, v70, v78
    v_fma_f32 v84, v84, v65, v73
    v_fma_f32 v85, v85, v67, v75
    v_fma_f32 v86, v86, v69, v77
    v_fma_f32 v87, v87, v71, v79
    v_cvt_pk_bf16_f32 v52, v28, v84
    v_cvt_pk_bf16_f32 v53, v29, v85
    v_cvt_pk_bf16_f32 v54, v30, v86
    v_cvt_pk_bf16_f32 v55, v31, v87
    v_fma_f32 v32, v32, v64, v72
    v_fma_f32 v33, v33, v66, v74
    v_fma_f32 v34, v34, v68, v76
    v_fma_f32 v35, v35, v70, v78
    v_fma_f32 v88, v88, v65, v73
    v_fma_f32 v89, v89, v67, v75
    v_fma_f32 v90, v90, v69, v77
    v_fma_f32 v91, v91, v71, v79
    v_cvt_pk_bf16_f32 v56, v32, v88
    v_cvt_pk_bf16_f32 v57, v33, v89
    v_cvt_pk_bf16_f32 v58, v34, v90
    v_cvt_pk_bf16_f32 v59, v35, v91
    v_fma_f32 v80, v80, v64, v72
    v_fma_f32 v81, v81, v66, v74
    v_fma_f32 v82, v82, v68, v76
    v_fma_f32 v83, v83, v70, v78
    v_fma_f32 v92, v92, v65, v73
    v_fma_f32 v93, v93, v67, v75
    v_fma_f32 v94, v94, v69, v77
    v_fma_f32 v95, v95, v71, v79
    v_cvt_pk_bf16_f32 v60, v80, v92
    v_cvt_pk_bf16_f32 v61, v81, v93
    v_cvt_pk_bf16_f32 v62, v82, v94
    v_cvt_pk_bf16_f32 v63, v83, v95
    s_mul_i32 s82, s73, 786432
    s_lshl_b32 s83, s72, 1
    s_add_u32 s83, s83, s79
    s_lshl_b32 s83, s83, 1
    s_add_u32 s83, s83, s80
    s_mul_i32 s83, s83, 6144
    s_add_u32 s82, s82, s83
    buffer_store_dwordx4 v[52:55], v22, s[44:47], s82 offen offset:0 sc1
    buffer_store_dwordx4 v[56:59], v23, s[44:47], s82 offen offset:1024 sc1
    buffer_store_dwordx4 v[60:63], v16, s[44:47], s82 offen offset:2048 sc1
    s_add_u32 m0, s87, 0
    s_add_u32 s86, s93, 393216
    buffer_load_dwordx4 v18, s[12:15], s86 offen offset:0 lds
    buffer_load_dwordx4 v18, s[12:15], s86 offen offset:1024 lds
    buffer_load_dwordx4 v18, s[12:15], s86 offen offset:2048 lds
    s_add_u32 m0, s87, 3072
    s_add_u32 s86, s93, 405504
    buffer_load_dwordx4 v18, s[12:15], s86 offen offset:0 lds
    buffer_load_dwordx4 v18, s[12:15], s86 offen offset:1024 lds
    buffer_load_dwordx4 v18, s[12:15], s86 offen offset:2048 lds
    s_add_u32 m0, s87, 24576
    s_add_u32 s86, s93, 589824
    buffer_load_dwordx4 v18, s[12:15], s86 offen offset:0 lds
    buffer_load_dwordx4 v18, s[12:15], s86 offen offset:1024 lds
    buffer_load_dwordx4 v18, s[12:15], s86 offen offset:2048 lds
    s_add_u32 m0, s87, 27648
    s_add_u32 s86, s93, 602112
    buffer_load_dwordx4 v18, s[12:15], s86 offen offset:0 lds
    buffer_load_dwordx4 v18, s[12:15], s86 offen offset:1024 lds
    buffer_load_dwordx4 v18, s[12:15], s86 offen offset:2048 lds
    s_waitcnt vmcnt(6)
    s_barrier
    s_add_u32 m0, s87, 49152
    s_add_u32 s86, s93, 786432
    buffer_load_dwordx4 v18, s[12:15], s86 offen offset:0 lds
    buffer_load_dwordx4 v18, s[12:15], s86 offen offset:1024 lds
    buffer_load_dwordx4 v18, s[12:15], s86 offen offset:2048 lds
    s_add_u32 m0, s87, 52224
    s_add_u32 s86, s93, 798720
    buffer_load_dwordx4 v18, s[12:15], s86 offen offset:0 lds
    buffer_load_dwordx4 v18, s[12:15], s86 offen offset:1024 lds
    buffer_load_dwordx4 v18, s[12:15], s86 offen offset:2048 lds
    s_cmp_lg_u32 s77, 0
    s_cbranch_scc1 L_nzf_0
    s_lshl_b32 s82, s73, 5
    s_add_u32 s82, s82, s72
    s_lshl_b32 s82, s82, 6
    s_add_u32 s82, s82, 0xb00000
    v_mov_b32 v26, s78
    v_mov_b32 v21, 0
    s_mov_b64 exec, 1
    buffer_store_dword v26, v21, s[44:47], s82 offen sc1
    s_mov_b64 exec, -1
L_nzf_0:
    s_waitcnt vmcnt(6)
    s_barrier
    s_add_u32 m0, s87, 0
    s_add_u32 s86, s93, 983040
    buffer_load_dwordx4 v18, s[12:15], s86 offen offset:0 lds
    buffer_load_dwordx4 v18, s[12:15], s86 offen offset:1024 lds
    buffer_load_dwordx4 v18, s[12:15], s86 offen offset:2048 lds
    s_add_u32 m0, s87, 3072
    s_add_u32 s86, s93, 995328
    buffer_load_dwordx4 v18, s[12:15], s86 offen offset:0 lds
    buffer_load_dwordx4 v18, s[12:15], s86 offen offset:1024 lds
    buffer_load_dwordx4 v18, s[12:15], s86 offen offset:2048 lds
    s_waitcnt vmcnt(6)
    s_barrier
    s_add_u32 m0, s87, 24576
    s_add_u32 s86, s93, 1179648
    buffer_load_dwordx4 v18, s[12:15], s86 offen offset:0 lds
    buffer_load_dwordx4 v18, s[12:15], s86 offen offset:1024 lds
    buffer_load_dwordx4 v18, s[12:15], s86 offen offset:2048 lds
    s_add_u32 m0, s87, 27648
    s_add_u32 s86, s93, 1191936
    buffer_load_dwordx4 v18, s[12:15], s86 offen offset:0 lds
    buffer_load_dwordx4 v18, s[12:15], s86 offen offset:1024 lds
    buffer_load_dwordx4 v18, s[12:15], s86 offen offset:2048 lds
    s_waitcnt vmcnt(6)
    s_barrier
    s_add_u32 m0, s87, 49152
    s_add_u32 s86, s93, 1376256
    buffer_load_dwordx4 v18, s[12:15], s86 offen offset:0 lds
    buffer_load_dwordx4 v18, s[12:15], s86 offen offset:1024 lds
    buffer_load_dwordx4 v18, s[12:15], s86 offen offset:2048 lds
    s_add_u32 m0, s87, 52224
    s_add_u32 s86, s93, 1388544
    buffer_load_dwordx4 v18, s[12:15], s86 offen offset:0 lds
    buffer_load_dwordx4 v18, s[12:15], s86 offen offset:1024 lds
    buffer_load_dwordx4 v18, s[12:15], s86 offen offset:2048 lds
    s_lshr_b32 s87, s87, 1
    s_lshl_b32 s92, s73, 1
    s_and_b32 s82, s72, 1
    s_add_u32 s92, s92, s82
    s_mul_i32 s92, s92, 196608
    s_add_u32 s92, s92, s87
    s_lshl_b32 s92, s92, 1
    s_waitcnt vmcnt(6)
    s_barrier
    s_lshl_b32 s71, s73, 1
    s_and_b32 s83, s72, 1
    s_add_u32 s71, s71, s83
    s_lshl_b32 s71, s71, 2
    s_add_u32 s71, s71, s77
    s_lshl_b32 s71, s71, 8
    s_add_u32 s71, s71, 0xb00000
    s_buffer_load_dword s48, s[44:47], s71 offset:0 glc
    s_buffer_load_dword s49, s[44:47], s71 offset:64 glc
    s_buffer_load_dword s50, s[44:47], s71 offset:128 glc
    s_buffer_load_dword s51, s[44:47], s71 offset:192 glc
    s_add_u32 m0, s95, 0
    s_add_u32 s86, s91, 0
    buffer_load_dwordx4 v4, s[24:27], s86 offen offset:0 lds
    buffer_load_dwordx4 v5, s[24:27], s86 offen offset:1024 lds
    buffer_load_dwordx4 v6, s[24:27], s86 offen offset:2048 lds
    buffer_load_dwordx4 v7, s[24:27], s86 offen offset:3072 lds
    s_waitcnt vmcnt(4)
    s_barrier
    s_add_u32 m0, s95, 16384
    s_add_u32 s86, s91, 128
    buffer_load_dwordx4 v4, s[24:27], s86 offen offset:0 lds
    buffer_load_dwordx4 v5, s[24:27], s86 offen offset:1024 lds
    buffer_load_dwordx4 v6, s[24:27], s86 offen offset:2048 lds
    buffer_load_dwordx4 v7, s[24:27], s86 offen offset:3072 lds
    s_add_u32 m0, s95, 32768
    s_add_u32 s86, s91, 256
    buffer_load_dwordx4 v4, s[24:27], s86 offen offset:0 lds
    buffer_load_dwordx4 v5, s[24:27], s86 offen offset:1024 lds
    buffer_load_dwordx4 v6, s[24:27], s86 offen offset:2048 lds
    buffer_load_dwordx4 v7, s[24:27], s86 offen offset:3072 lds
    s_mov_b32 s88, 32768
L_p1_0:
    s_waitcnt lgkmcnt(0)
    s_xor_b32 s82, s48, s78
    s_xor_b32 s83, s49, s78
    s_or_b32 s82, s82, s83
    s_xor_b32 s83, s50, s78
    s_or_b32 s82, s82, s83
    s_xor_b32 s83, s51, s78
    s_or_b32 s82, s82, s83
    s_cbranch_scc0 L_p1_0_ok
    s_buffer_load_dword s48, s[44:47], s71 offset:0 glc
    s_buffer_load_dword s49, s[44:47], s71 offset:64 glc
    s_buffer_load_dword s50, s[44:47], s71 offset:128 glc
    s_buffer_load_dword s51, s[44:47], s71 offset:192 glc
    s_sub_u32 s88, s88, 1
    s_cbranch_scc0 L_p1_0
    s_waitcnt lgkmcnt(0)
L_p1_0_ok:
    s_barrier
    s_add_u32 m0, s87, 81920
    s_add_u32 s86, s92, 0
    buffer_load_dwordx4 v22, s[44:47], s86 offen offset:0 sc1 lds
    buffer_load_dwordx4 v23, s[44:47], s86 offen offset:1024 sc1 lds
    buffer_load_dwordx4 v8, s[44:47], s86 offen offset:2048 sc1 lds
    s_add_u32 m0, s87, 94208
    s_add_u32 s86, s92, 24576
    buffer_load_dwordx4 v22, s[44:47], s86 offen offset:0 sc1 lds
    buffer_load_dwordx4 v23, s[44:47], s86 offen offset:1024 sc1 lds
    buffer_load_dwordx4 v8, s[44:47], s86 offen offset:2048 sc1 lds
    s_add_u32 m0, s87, 106496
    s_add_u32 s86, s92, 49152
    buffer_load_dwordx4 v22, s[44:47], s86 offen offset:0 sc1 lds
    buffer_load_dwordx4 v23, s[44:47], s86 offen offset:1024 sc1 lds
    buffer_load_dwordx4 v8, s[44:47], s86 offen offset:2048 sc1 lds
    s_branch L_join
L_var1:
    s_barrier
    s_add_u32 m0, s87, 49152
    s_xor_b32 s85, s100, 2
    s_mul_i32 s85, s85, 352256
    s_add_u32 s86, s91, s85
    buffer_load_dwordx4 v37, s[20:23], s86 offen offset:0 lds
    buffer_load_dwordx4 v38, s[20:23], s86 offen offset:1024 lds
    buffer_load_dwordx4 v39, s[20:23], s86 offen offset:2048 lds
    s_add_u32 m0, s87, 52224
    s_add_u32 s86, s86, 44032
    buffer_load_dwordx4 v37, s[20:23], s86 offen offset:0 lds
    buffer_load_dwordx4 v38, s[20:23], s86 offen offset:1024 lds
    buffer_load_dwordx4 v39, s[20:23], s86 offen offset:2048 lds
    s_barrier
    s_add_u32 m0, s87, 0
    s_xor_b32 s85, s100, 3
    s_mul_i32 s85, s85, 352256
    s_add_u32 s86, s91, s85
    buffer_load_dwordx4 v37, s[20:23], s86 offen offset:0 lds
    buffer_load_dwordx4 v38, s[20:23], s86 offen offset:1024 lds
    buffer_load_dwordx4 v39, s[20:23], s86 offen offset:2048 lds
    s_add_u32 m0, s87, 3072
    s_add_u32 s86, s86, 44032
    buffer_load_dwordx4 v37, s[20:23], s86 offen offset:0 lds
    buffer_load_dwordx4 v38, s[20:23], s86 offen offset:1024 lds
    buffer_load_dwordx4 v39, s[20:23], s86 offen offset:2048 lds
    s_xor_b32 s91, s72, s80
    s_lshl_b32 s91, s91, 18
    s_and_b32 s82, s72, 1
    s_lshl_b32 s82, s82, 11
    s_add_u32 s91, s91, s82
    s_waitcnt vmcnt(6)
    s_barrier
    s_add_u32 m0, s87, 24576
    s_add_u32 s86, s93, 0
    buffer_load_dwordx4 v18, s[12:15], s86 offen offset:0 lds
    buffer_load_dwordx4 v18, s[12:15], s86 offen offset:1024 lds
    buffer_load_dwordx4 v18, s[12:15], s86 offen offset:2048 lds
    s_add_u32 m0, s87, 27648
    s_add_u32 s86, s93, 12288
    buffer_load_dwordx4 v18, s[12:15], s86 offen offset:0 lds
    buffer_load_dwordx4 v18, s[12:15], s86 offen offset:1024 lds
    buffer_load_dwordx4 v18, s[12:15], s86 offen offset:2048 lds
    s_waitcnt vmcnt(6)
    s_barrier
    s_add_u32 m0, s87, 49152
    s_add_u32 s86, s93, 196608
    buffer_load_dwordx4 v18, s[12:15], s86 offen offset:0 lds
    buffer_load_dwordx4 v18, s[12:15], s86 offen offset:1024 lds
    buffer_load_dwordx4 v18, s[12:15], s86 offen offset:2048 lds
    s_add_u32 m0, s87, 52224
    s_add_u32 s86, s93, 208896
    buffer_load_dwordx4 v18, s[12:15], s86 offen offset:0 lds
    buffer_load_dwordx4 v18, s[12:15], s86 offen offset:1024 lds
    buffer_load_dwordx4 v18, s[12:15], s86 offen offset:2048 lds
    buffer_load_dwordx4 v[48:51], v15, s[44:47], s89 offen offset:0 sc1
    buffer_load_dwordx4 v[52:55], v15, s[44:47], s89 offen offset:1024 sc1
    buffer_load_dwordx4 v[56:59], v15, s[44:47], s89 offen offset:2048 sc1
    buffer_load_dwordx4 v[60:63], v15, s[44:47], s89 offen offset:3072 sc1
    s_waitcnt vmcnt(10)
    s_barrier
    s_add_u32 m0, s87, 0
    s_add_u32 s86, s93, 393216
    buffer_load_dwordx4 v18, s[12:15], s86 offen offset:0 lds
    buffer_load_dwordx4 v18, s[12:15], s86 offen offset:1024 lds
    buffer_load_dwordx4 v18, s[12:15], s86 offen offset:2048 lds
    s_add_u32 m0, s87, 3072
    s_add_u32 s86, s93, 405504
    buffer_load_dwordx4 v18, s[12:15], s86 offen offset:0 lds
    buffer_load_dwordx4 v18, s[12:15], s86 offen offset:1024 lds
    buffer_load_dwordx4 v18, s[12:15], s86 offen offset:2048 lds
    s_waitcnt vmcnt(10)
    s_barrier
    s_add_u32 m0, s87, 24576
    s_add_u32 s86, s93, 589824
    buffer_load_dwordx4 v18, s[12:15], s86 offen offset:0 lds
    s_waitcnt vmcnt(7)
    v_xor_b32 v48, s52, v48
    v_xor_b32 v49, s53, v49
    v_xor_b32 v50, s54, v50
    v_xor_b32 v51, s55, v51
    v_or_b32 v14, v48, v49
    v_or3_b32 v14, v14, v50, v51
    buffer_load_dwordx4 v18, s[12:15], s86 offen offset:1024 lds
    v_xor_b32 v52, s52, v52
    v_xor_b32 v53, s53, v53
    v_xor_b32 v54, s54, v54
    v_xor_b32 v55, s55, v55
    v_or3_b32 v14, v14, v52, v53
    v_or3_b32 v14, v14, v54, v55
    buffer_load_dwordx4 v18, s[12:15], s86 offen offset:2048 lds
    v_xor_b32 v56, s52, v56
    v_xor_b32 v57, s53, v57
    v_xor_b32 v58, s54, v58
    v_xor_b32 v59, s55, v59
    v_or3_b32 v14, v14, v56, v57
    v_or3_b32 v14, v14, v58, v59
    s_add_u32 m0, s87, 27648
    s_add_u32 s86, s93, 602112
    buffer_load_dwordx4 v18, s[12:15], s86 offen offset:0 lds
    v_xor_b32 v60, s52, v60
    v_xor_b32 v61, s53, v61
    v_xor_b32 v62, s54, v62
    v_xor_b32 v63, s55, v63
    v_or3_b32 v14, v14, v60, v61
    v_or3_b32 v14, v14, v62, v63
    buffer_load_dwordx4 v18, s[12:15], s86 offen offset:1024 lds
    v_and_b32 v14, v14, v17
    v_cmp_ne_u32 vcc, 0, v14
    s_cbranch_vccz L_gok_1
    s_mov_b32 s88, 32768
L_gchk_1:
    buffer_load_dwordx4 v[48:51], v15, s[44:47], s89 offen offset:0 sc1
    buffer_load_dwordx4 v[52:55], v15, s[44:47], s89 offen offset:1024 sc1
    buffer_load_dwordx4 v[56:59], v15, s[44:47], s89 offen offset:2048 sc1
    buffer_load_dwordx4 v[60:63], v15, s[44:47], s89 offen offset:3072 sc1
    s_waitcnt vmcnt(0)
    v_xor_b32 v48, s52, v48
    v_xor_b32 v49, s53, v49
    v_xor_b32 v50, s54, v50
    v_xor_b32 v51, s55, v51
    v_or_b32 v14, v48, v49
    v_or3_b32 v14, v14, v50, v51
    v_xor_b32 v52, s52, v52
    v_xor_b32 v53, s53, v53
    v_xor_b32 v54, s54, v54
    v_xor_b32 v55, s55, v55
    v_or3_b32 v14, v14, v52, v53
    v_or3_b32 v14, v14, v54, v55
    v_xor_b32 v56, s52, v56
    v_xor_b32 v57, s53, v57
    v_xor_b32 v58, s54, v58
    v_xor_b32 v59, s55, v59
    v_or3_b32 v14, v14, v56, v57
    v_or3_b32 v14, v14, v58, v59
    v_xor_b32 v60, s52, v60
    v_xor_b32 v61, s53, v61
    v_xor_b32 v62, s54, v62
    v_xor_b32 v63, s55, v63
    v_or3_b32 v14, v14, v60, v61
    v_or3_b32 v14, v14, v62, v63
    v_and_b32 v14, v14, v17
    v_cmp_ne_u32 vcc, 0, v14
    s_cbranch_vccz L_gok_1
    s_sub_u32 s88, s88, 1
    s_cbranch_scc0 L_gchk_1
L_gok_1:
    v_add_f32 v48, v48, v56
    v_add_f32 v49, v49, v57
    v_add_f32 v50, v50, v58
    v_add_f32 v51, v51, v59
    v_add_f32 v52, v52, v60
    buffer_load_dwordx4 v18, s[12:15], s86 offen offset:2048 lds
    v_add_f32 v53, v53, v61
    v_add_f32 v54, v54, v62
    v_add_f32 v55, v55, v63
    v_add_f32 v48, v48, v52
    v_add_f32 v49, v49, v53
    v_add_f32 v50, v50, v54
    v_add_f32 v51, v51, v55
    s_waitcnt vmcnt(6)
    s_barrier
    s_add_u32 m0, s87, 49152
    s_add_u32 s86, s93, 786432
    buffer_load_dwordx4 v18, s[12:15], s86 offen offset:0 lds
    v_add_f32_dpp v48, v48, v48 row_ror:4 row_mask:0xf bank_mask:0xf
    v_add_f32_dpp v49, v49, v49 row_ror:4 row_mask:0xf bank_mask:0xf
    v_add_f32_dpp v50, v50, v50 row_ror:4 row_mask:0xf bank_mask:0xf
    v_add_f32_dpp v51, v51, v51 row_ror:4 row_mask:0xf bank_mask:0xf
    v_add_f32_dpp v48, v48, v48 row_ror:8 row_mask:0xf bank_mask:0xf
    v_add_f32_dpp v49, v49, v49 row_ror:8 row_mask:0xf bank_mask:0xf
    buffer_load_dwordx4 v18, s[12:15], s86 offen offset:1024 lds
    v_add_f32_dpp v50, v50, v50 row_ror:8 row_mask:0xf bank_mask:0xf
    v_add_f32_dpp v51, v51, v51 row_ror:8 row_mask:0xf bank_mask:0xf
    v_mul_f32 v48, 0x3abe82fa, v48
    v_mul_f32 v49, 0x3abe82fa, v49
    v_mul_f32 v50, 0x3abe82fa, v50
    v_mul_f32 v51, 0x3abe82fa, v51
    buffer_load_dwordx4 v18, s[12:15], s86 offen offset:2048 lds
    v_fma_f32 v49, -v48, v48, v49
    v_fma_f32 v51, -v50, v50, v51
    v_max_f32 v49, 0, v49
    v_max_f32 v51, 0, v51
    v_add_f32 v49, 0x3727c5ac, v49
    v_add_f32 v51, 0x3727c5ac, v51
    s_add_u32 m0, s87, 52224
    s_add_u32 s86, s93, 798720
    buffer_load_dwordx4 v18, s[12:15], s86 offen offset:0 lds
    v_rsq_f32 v10, v49
    v_rsq_f32 v11, v51
    v_mul_f32 v12, -v48, v10
    v_mul_f32 v13, -v50, v11
    v_mov_b32_dpp v64, v10 row_newbcast:0 row_mask:0xf bank_mask:0xf
    v_mov_b32_dpp v65, v11 row_newbcast:0 row_mask:0xf bank_mask:0xf
    buffer_load_dwordx4 v18, s[12:15], s86 offen offset:1024 lds
    v_mov_b32_dpp v66, v10 row_newbcast:1 row_mask:0xf bank_mask:0xf
    v_mov_b32_dpp v67, v11 row_newbcast:1 row_mask:0xf bank_mask:0xf
    v_mov_b32_dpp v68, v10 row_newbcast:2 row_mask:0xf bank_mask:0xf
    v_mov_b32_dpp v69, v11 row_newbcast:2 row_mask:0xf bank_mask:0xf
    v_mov_b32_dpp v70, v10 row_newbcast:3 row_mask:0xf bank_mask:0xf
    v_mov_b32_dpp v71, v11 row_newbcast:3 row_mask:0xf bank_mask:0xf
    buffer_load_dwordx4 v18, s[12:15], s86 offen offset:2048 lds
    v_mov_b32_dpp v72, v12 row_newbcast:0 row_mask:0xf bank_mask:0xf
    v_mov_b32_dpp v73, v13 row_newbcast:0 row_mask:0xf bank_mask:0xf
    v_mov_b32_dpp v74, v12 row_newbcast:1 row_mask:0xf bank_mask:0xf
    v_mov_b32_dpp v75, v13 row_newbcast:1 row_mask:0xf bank_mask:0xf
    v_mov_b32_dpp v76, v12 row_newbcast:2 row_mask:0xf bank_mask:0xf
    v_mov_b32_dpp v77, v13 row_newbcast:2 row_mask:0xf bank_mask:0xf
    v_mov_b32_dpp v78, v12 row_newbcast:3 row_mask:0xf bank_mask:0xf
    v_mov_b32_dpp v79, v13 row_newbcast:3 row_mask:0xf bank_mask:0xf
    s_waitcnt vmcnt(6)
    s_barrier
    s_add_u32 m0, s87, 0
    s_add_u32 s86, s93, 983040
    buffer_load_dwordx4 v18, s[12:15], s86 offen offset:0 lds
    v_fma_f32 v28, v28, v64, v72
    v_fma_f32 v29, v29, v66, v74
    v_fma_f32 v30, v30, v68, v76
    v_fma_f32 v31, v31, v70, v78
    v_fma_f32 v84, v84, v65, v73
    v_fma_f32 v85, v85, v67, v75
    buffer_load_dwordx4 v18, s[12:15], s86 offen offset:1024 lds
    v_fma_f32 v86, v86, v69, v77
    v_fma_f32 v87, v87, v71, v79
    v_cvt_pk_bf16_f32 v52, v28, v84
    v_cvt_pk_bf16_f32 v53, v29, v85
    v_cvt_pk_bf16_f32 v54, v30, v86
    v_cvt_pk_bf16_f32 v55, v31, v87
    buffer_load_dwordx4 v18, s[12:15], s86 offen offset:2048 lds
    v_fma_f32 v32, v32, v64, v72
    v_fma_f32 v33, v33, v66, v74
    v_fma_f32 v34, v34, v68, v76
    v_fma_f32 v35, v35, v70, v78
    v_fma_f32 v88, v88, v65, v73
    v_fma_f32 v89, v89, v67, v75
    s_add_u32 m0, s87, 3072
    s_add_u32 s86, s93, 995328
    buffer_load_dwordx4 v18, s[12:15], s86 offen offset:0 lds
    v_fma_f32 v90, v90, v69, v77
    v_fma_f32 v91, v91, v71, v79
    v_cvt_pk_bf16_f32 v56, v32, v88
    v_cvt_pk_bf16_f32 v57, v33, v89
    v_cvt_pk_bf16_f32 v58, v34, v90
    v_cvt_pk_bf16_f32 v59, v35, v91
    buffer_load_dwordx4 v18, s[12:15], s86 offen offset:1024 lds
    v_fma_f32 v80, v80, v64, v72
    v_fma_f32 v81, v81, v66, v74
    v_fma_f32 v82, v82, v68, v76
    v_fma_f32 v83, v83, v70, v78
    v_fma_f32 v92, v92, v65, v73
    v_fma_f32 v93, v93, v67, v75
    buffer_load_dwordx4 v18, s[12:15], s86 offen offset:2048 lds
    v_fma_f32 v94, v94, v69, v77
    v_fma_f32 v95, v95, v71, v79
    v_cvt_pk_bf16_f32 v60, v80, v92
    v_cvt_pk_bf16_f32 v61, v81, v93
    v_cvt_pk_bf16_f32 v62, v82, v94
    v_cvt_pk_bf16_f32 v63, v83, v95
    s_mul_i32 s82, s73, 786432
    s_lshl_b32 s83, s72, 1
    s_add_u32 s83, s83, s79
    s_lshl_b32 s83, s83, 1
    s_add_u32 s83, s83, s80
    s_mul_i32 s83, s83, 6144
    s_add_u32 s82, s82, s83
    buffer_store_dwordx4 v[52:55], v22, s[44:47], s82 offen offset:0 sc1
    buffer_store_dwordx4 v[56:59], v23, s[44:47], s82 offen offset:1024 sc1
    buffer_store_dwordx4 v[60:63], v16, s[44:47], s82 offen offset:2048 sc1
    s_waitcnt vmcnt(9)
    s_barrier
    s_add_u32 m0, s87, 24576
    s_add_u32 s86, s93, 1179648
    buffer_load_dwordx4 v18, s[12:15], s86 offen offset:0 lds
    buffer_load_dwordx4 v18, s[12:15], s86 offen offset:1024 lds
    buffer_load_dwordx4 v18, s[12:15], s86 offen offset:2048 lds
    s_add_u32 m0, s87, 27648
    s_add_u32 s86, s93, 1191936
    buffer_load_dwordx4 v18, s[12:15], s86 offen offset:0 lds
L_pg2:
    s_cbranch_execz L_warmed
    buffer_load_dwordx4 v18, s[12:15], s86 offen offset:1024 lds
    buffer_load_dwordx4 v18, s[12:15], s86 offen offset:2048 lds
    s_waitcnt vmcnt(9)
    s_waitcnt vmcnt(6)
    s_barrier
    s_add_u32 m0, s87, 49152
    s_add_u32 s86, s93, 1376256
    buffer_load_dwordx4 v18, s[12:15], s86 offen offset:0 lds
    buffer_load_dwordx4 v18, s[12:15], s86 offen offset:1024 lds
    buffer_load_dwordx4 v18, s[12:15], s86 offen offset:2048 lds
    s_add_u32 m0, s87, 52224
    s_add_u32 s86, s93, 1388544
    buffer_load_dwordx4 v18, s[12:15], s86 offen offset:0 lds
    buffer_load_dwordx4 v18, s[12:15], s86 offen offset:1024 lds
    buffer_load_dwordx4 v18, s[12:15], s86 offen offset:2048 lds
    s_cmp_lg_u32 s77, 0
    s_cbranch_scc1 L_nzf_1
    s_lshl_b32 s82, s73, 5
    s_add_u32 s82, s82, s72
    s_lshl_b32 s82, s82, 6
    s_add_u32 s82, s82, 0xb00000
    v_mov_b32 v26, s78
    v_mov_b32 v21, 0
    s_mov_b64 exec, 1
    buffer_store_dword v26, v21, s[44:47], s82 offen sc1
    s_mov_b64 exec, -1
L_nzf_1:
    s_lshr_b32 s87, s87, 1
    s_lshl_b32 s92, s73, 1
    s_and_b32 s82, s72, 1
    s_add_u32 s92, s92, s82
    s_mul_i32 s92, s92, 196608
    s_add_u32 s92, s92, s87
    s_lshl_b32 s92, s92, 1
    s_waitcnt vmcnt(6)
    s_barrier
    s_lshl_b32 s71, s73, 1
    s_and_b32 s83, s72, 1
    s_add_u32 s71, s71, s83
    s_lshl_b32 s71, s71, 2
    s_add_u32 s71, s71, s77
    s_lshl_b32 s71, s71, 8
    s_add_u32 s71, s71, 0xb00000
    s_buffer_load_dword s48, s[44:47], s71 offset:0 glc
    s_buffer_load_dword s49, s[44:47], s71 offset:64 glc
    s_buffer_load_dword s50, s[44:47], s71 offset:128 glc
    s_buffer_load_dword s51, s[44:47], s71 offset:192 glc
    buffer_load_dword v255, v19, s[24:27], s70 offen
    s_waitcnt vmcnt(1)
    s_barrier
    s_mov_b32 s88, 32768
L_p1_1:
    s_waitcnt lgkmcnt(0)
    s_xor_b32 s82, s48, s78
    s_xor_b32 s83, s49, s78
    s_or_b32 s82, s82, s83
    s_xor_b32 s83, s50, s78
    s_or_b32 s82, s82, s83
    s_xor_b32 s83, s51, s78
    s_or_b32 s82, s82, s83
    s_cbranch_scc0 L_p1_1_ok
    s_buffer_load_dword s48, s[44:47], s71 offset:0 glc
    s_buffer_load_dword s49, s[44:47], s71 offset:64 glc
    s_buffer_load_dword s50, s[44:47], s71 offset:128 glc
    s_buffer_load_dword s51, s[44:47], s71 offset:192 glc
    s_sub_u32 s88, s88, 1
    s_cbranch_scc0 L_p1_1
    s_waitcnt lgkmcnt(0)
L_p1_1_ok:
    s_barrier
    s_add_u32 m0, s87, 81920
    s_add_u32 s86, s92, 0
    buffer_load_dwordx4 v22, s[44:47], s86 offen offset:0 sc1 lds
    buffer_load_dwordx4 v23, s[44:47], s86 offen offset:1024 sc1 lds
    buffer_load_dwordx4 v8, s[44:47], s86 offen offset:2048 sc1 lds
    s_add_u32 m0, s95, 0
    s_add_u32 s86, s91, 0
    buffer_load_dwordx4 v4, s[24:27], s86 offen offset:0 lds
    buffer_load_dwordx4 v5, s[24:27], s86 offen offset:1024 lds
    buffer_load_dwordx4 v6, s[24:27], s86 offen offset:2048 lds
    buffer_load_dwordx4 v7, s[24:27], s86 offen offset:3072 lds
    s_add_u32 m0, s87, 94208
    s_add_u32 s86, s92, 24576
    buffer_load_dwordx4 v22, s[44:47], s86 offen offset:0 sc1 lds
    buffer_load_dwordx4 v23, s[44:47], s86 offen offset:1024 sc1 lds
    buffer_load_dwordx4 v8, s[44:47], s86 offen offset:2048 sc1 lds
    s_add_u32 m0, s95, 16384
    s_add_u32 s86, s91, 128
    buffer_load_dwordx4 v4, s[24:27], s86 offen offset:0 lds
    buffer_load_dwordx4 v5, s[24:27], s86 offen offset:1024 lds
    buffer_load_dwordx4 v6, s[24:27], s86 offen offset:2048 lds
    buffer_load_dwordx4 v7, s[24:27], s86 offen offset:3072 lds
    s_add_u32 m0, s87, 106496
    s_add_u32 s86, s92, 49152
    buffer_load_dwordx4 v22, s[44:47], s86 offen offset:0 sc1 lds
    buffer_load_dwordx4 v23, s[44:47], s86 offen offset:1024 sc1 lds
    buffer_load_dwordx4 v8, s[44:47], s86 offen offset:2048 sc1 lds
    s_add_u32 m0, s95, 32768
    s_add_u32 s86, s91, 256
    buffer_load_dwordx4 v4, s[24:27], s86 offen offset:0 lds
    buffer_load_dwordx4 v5, s[24:27], s86 offen offset:1024 lds
    buffer_load_dwordx4 v6, s[24:27], s86 offen offset:2048 lds
    buffer_load_dwordx4 v7, s[24:27], s86 offen offset:3072 lds
L_join:
    s_setprio 2
    s_mul_i32 s89, s72, 311296
    s_add_u32 s89, s89, 0x1800000
    s_add_u32 s89, s89, s95
    s_add_u32 s89, s89, s95
    s_lshl_b32 s90, s73, 7
    s_add_u32 m0, s87, 118784
    s_add_u32 s86, s92, 73728
    buffer_load_dwordx4 v22, s[44:47], s86 offen offset:0 sc1 lds
    buffer_load_dwordx4 v23, s[44:47], s86 offen offset:1024 sc1 lds
    buffer_load_dwordx4 v8, s[44:47], s86 offen offset:2048 sc1 lds
    s_add_u32 m0, s95, 49152
    s_add_u32 s86, s91, 384
    buffer_load_dwordx4 v4, s[24:27], s86 offen offset:0 lds
    buffer_load_dwordx4 v5, s[24:27], s86 offen offset:1024 lds
    s_waitcnt vmcnt(11)
    s_barrier
    buffer_load_dwordx4 v6, s[24:27], s86 offen offset:2048 lds
    buffer_load_dwordx4 v7, s[24:27], s86 offen offset:3072 lds
    s_add_u32 m0, s87, 131072
    s_add_u32 s86, s92, 98304
    buffer_load_dwordx4 v22, s[44:47], s86 offen offset:0 sc1 lds
    buffer_load_dwordx4 v23, s[44:47], s86 offen offset:1024 sc1 lds
    buffer_load_dwordx4 v8, s[44:47], s86 offen offset:2048 sc1 lds
    s_add_u32 m0, s95, 65536
    s_add_u32 s86, s91, 512
    buffer_load_dwordx4 v4, s[24:27], s86 offen offset:0 lds
    buffer_load_dwordx4 v5, s[24:27], s86 offen offset:1024 lds
    s_waitcnt vmcnt(15)
    s_barrier
    buffer_load_dwordx4 v6, s[24:27], s86 offen offset:2048 lds
    buffer_load_dwordx4 v7, s[24:27], s86 offen offset:3072 lds
    s_add_u32 m0, s87, 81920
    s_add_u32 s86, s92, 122880
    buffer_load_dwordx4 v22, s[44:47], s86 offen offset:0 sc1 lds
    buffer_load_dwordx4 v23, s[44:47], s86 offen offset:1024 sc1 lds
    buffer_load_dwordx4 v8, s[44:47], s86 offen offset:2048 sc1 lds
    s_add_u32 m0, s95, 0
    s_add_u32 s86, s91, 640
    buffer_load_dwordx4 v4, s[24:27], s86 offen offset:0 lds
    buffer_load_dwordx4 v5, s[24:27], s86 offen offset:1024 lds
    s_waitcnt vmcnt(19)
    s_barrier
    s_cmp_lg_u32 s77, 0
    s_cbranch_scc1 L_nof
    s_lshl_b32 s82, s72, 3
    s_add_u32 s82, s82, s73
    s_lshl_b32 s82, s82, 6
    s_add_u32 s82, s82, 0xb20000
    v_mov_b32 v40, s78
    v_mov_b32 v41, s78
    v_mov_b32 v42, s78
    v_mov_b32 v43, s78
    v_mov_b32 v21, 0
    s_mov_b64 exec, 1
    buffer_store_dwordx4 v[40:43], v21, s[44:47], s82 offen sc1
    s_mov_b64 exec, -1
L_nof:
    v_and_b32 v21, 3, v1
    v_lshlrev_b32 v21, 7, v21
    v_lshrrev_b32 v26, 2, v1
    v_lshl_add_u32 v21, v26, 10, v21
    s_lshl_b32 s83, s97, 9
    s_lshl_b32 s82, s96, 14
    s_add_u32 s82, s82, s83
    s_cmp_eq_u32 s97, 0
    s_cselect_b32 exec_lo, 0x88888888, 1
    s_cselect_b32 exec_hi, 0x88888888, 0
    s_cmp_eq_u32 s77, 0
    s_cbranch_scc0 L_t5b
    buffer_load_dword v255, v21, s[16:19], s82 offen
    s_branch L_t7b
L_t5b:
    s_sub_u32 s83, s77, 1
    s_lshl_b32 s83, s83, 19
    s_add_u32 s82, s82, s83
    buffer_load_dword v255, v21, s[32:35], s82 offen
L_t7b:
    s_mov_b64 exec, -1
    buffer_load_dwordx4 v6, s[24:27], s86 offen offset:2048 lds
    buffer_load_dwordx4 v7, s[24:27], s86 offen offset:3072 lds
    s_add_u32 m0, s87, 94208
    s_add_u32 s86, s92, 147456
    buffer_load_dwordx4 v22, s[44:47], s86 offen offset:0 sc1 lds
    buffer_load_dwordx4 v23, s[44:47], s86 offen offset:1024 sc1 lds
    buffer_load_dwordx4 v8, s[44:47], s86 offen offset:2048 sc1 lds
    s_add_u32 m0, s95, 16384
    s_add_u32 s86, s91, 768
    buffer_load_dwordx4 v4, s[24:27], s86 offen offset:0 lds
    buffer_load_dwordx4 v5, s[24:27], s86 offen offset:1024 lds
    s_waitcnt vmcnt(20)
    s_barrier
    buffer_load_dwordx4 v6, s[24:27], s86 offen offset:2048 lds
    buffer_load_dwordx4 v7, s[24:27], s86 offen offset:3072 lds
    s_add_u32 m0, s87, 106496
    s_add_u32 s86, s92, 172032
    buffer_load_dwordx4 v22, s[44:47], s86 offen offset:0 sc1 lds
    buffer_load_dwordx4 v23, s[44:47], s86 offen offset:1024 sc1 lds
    buffer_load_dwordx4 v8, s[44:47], s86 offen offset:2048 sc1 lds
    s_add_u32 m0, s95, 32768
    s_add_u32 s86, s91, 896
    buffer_load_dwordx4 v4, s[24:27], s86 offen offset:0 lds
    buffer_load_dwordx4 v5, s[24:27], s86 offen offset:1024 lds
    s_waitcnt vmcnt(20)
    s_barrier
    buffer_load_dwordx4 v6, s[24:27], s86 offen offset:2048 lds
    buffer_load_dwordx4 v7, s[24:27], s86 offen offset:3072 lds
    s_add_u32 m0, s87, 118784
    s_add_u32 s86, s92, 196608
    buffer_load_dwordx4 v22, s[44:47], s86 offen offset:0 sc1 lds
    buffer_load_dwordx4 v23, s[44:47], s86 offen offset:1024 sc1 lds
    buffer_load_dwordx4 v8, s[44:47], s86 offen offset:2048 sc1 lds
    s_add_u32 m0, s95, 49152
    s_add_u32 s86, s91, 1024
    buffer_load_dwordx4 v4, s[24:27], s86 offen offset:0 lds
    buffer_load_dwordx4 v5, s[24:27], s86 offen offset:1024 lds
    s_waitcnt vmcnt(19)
    s_barrier
    buffer_load_dwordx4 v6, s[24:27], s86 offen offset:2048 lds
    buffer_load_dwordx4 v7, s[24:27], s86 offen offset:3072 lds
    s_add_u32 m0, s87, 131072
    s_add_u32 s86, s92, 221184
    buffer_load_dwordx4 v22, s[44:47], s86 offen offset:0 sc1 lds
    buffer_load_dwordx4 v23, s[44:47], s86 offen offset:1024 sc1 lds
    buffer_load_dwordx4 v8, s[44:47], s86 offen offset:2048 sc1 lds
    s_add_u32 m0, s95, 65536
    s_add_u32 s86, s91, 1152
    buffer_load_dwordx4 v4, s[24:27], s86 offen offset:0 lds
    buffer_load_dwordx4 v5, s[24:27], s86 offen offset:1024 lds
    s_waitcnt vmcnt(19)
    s_barrier
    buffer_load_dwordx4 v6, s[24:27], s86 offen offset:2048 lds
    buffer_load_dwordx4 v7, s[24:27], s86 offen offset:3072 lds
    s_add_u32 m0, s87, 81920
    s_add_u32 s86, s92, 245760
    buffer_load_dwordx4 v22, s[44:47], s86 offen offset:0 sc1 lds
    buffer_load_dwordx4 v23, s[44:47], s86 offen offset:1024 sc1 lds
    buffer_load_dwordx4 v8, s[44:47], s86 offen offset:2048 sc1 lds
    s_add_u32 m0, s95, 0
    s_add_u32 s86, s91, 1280
    buffer_load_dwordx4 v4, s[24:27], s86 offen offset:0 lds
    buffer_load_dwordx4 v5, s[24:27], s86 offen offset:1024 lds
    s_waitcnt vmcnt(19)
    s_barrier
    buffer_load_dwordx4 v6, s[24:27], s86 offen offset:2048 lds
    buffer_load_dwordx4 v7, s[24:27], s86 offen offset:3072 lds
    s_add_u32 m0, s87, 94208
    s_add_u32 s86, s92, 270336
    buffer_load_dwordx4 v22, s[44:47], s86 offen offset:0 sc1 lds
    buffer_load_dwordx4 v23, s[44:47], s86 offen offset:1024 sc1 lds
    buffer_load_dwordx4 v8, s[44:47], s86 offen offset:2048 sc1 lds
    s_add_u32 m0, s95, 16384
    s_add_u32 s86, s91, 1408
    buffer_load_dwordx4 v4, s[24:27], s86 offen offset:0 lds
    buffer_load_dwordx4 v5, s[24:27], s86 offen offset:1024 lds
    s_waitcnt vmcnt(19)
    s_barrier
    buffer_load_dwordx4 v6, s[24:27], s86 offen offset:2048 lds
    buffer_load_dwordx4 v7, s[24:27], s86 offen offset:3072 lds
    s_add_u32 m0, s87, 106496
    s_add_u32 s86, s92, 294912
    buffer_load_dwordx4 v22, s[44:47], s86 offen offset:0 sc1 lds
    buffer_load_dwordx4 v23, s[44:47], s86 offen offset:1024 sc1 lds
    buffer_load_dwordx4 v8, s[44:47], s86 offen offset:2048 sc1 lds
    s_add_u32 m0, s95, 32768
    s_add_u32 s86, s91, 1536
    buffer_load_dwordx4 v4, s[24:27], s86 offen offset:0 lds
    buffer_load_dwordx4 v5, s[24:27], s86 offen offset:1024 lds
    s_waitcnt vmcnt(19)
    s_barrier
    s_lshl_b32 s70, s72, 2
    s_add_u32 s70, s70, s77
    s_lshl_b32 s70, s70, 7
    s_add_u32 s70, s70, 0xb20000
    s_buffer_load_dwordx4 s[48:51], s[44:47], s70 glc
    s_buffer_load_dwordx4 s[52:55], s[44:47], s70 offset:64 glc
    buffer_load_dwordx4 v6, s[24:27], s86 offen offset:2048 lds
    buffer_load_dwordx4 v7, s[24:27], s86 offen offset:3072 lds
    s_add_u32 m0, s87, 118784
    s_add_u32 s86, s92, 319488
    buffer_load_dwordx4 v22, s[44:47], s86 offen offset:0 sc1 lds
    buffer_load_dwordx4 v23, s[44:47], s86 offen offset:1024 sc1 lds
    buffer_load_dwordx4 v8, s[44:47], s86 offen offset:2048 sc1 lds
    s_add_u32 m0, s95, 49152
    s_add_u32 s86, s91, 1664
    buffer_load_dwordx4 v4, s[24:27], s86 offen offset:0 lds
    buffer_load_dwordx4 v5, s[24:27], s86 offen offset:1024 lds
    s_waitcnt vmcnt(19)
    s_barrier
    buffer_load_dwordx4 v6, s[24:27], s86 offen offset:2048 lds
    buffer_load_dwordx4 v7, s[24:27], s86 offen offset:3072 lds
    s_add_u32 m0, s87, 131072
    s_add_u32 s86, s92, 344064
    buffer_load_dwordx4 v22, s[44:47], s86 offen offset:0 sc1 lds
    buffer_load_dwordx4 v23, s[44:47], s86 offen offset:1024 sc1 lds
    buffer_load_dwordx4 v8, s[44:47], s86 offen offset:2048 sc1 lds
    s_add_u32 m0, s95, 65536
    s_add_u32 s86, s91, 1792
    buffer_load_dwordx4 v4, s[24:27], s86 offen offset:0 lds
    buffer_load_dwordx4 v5, s[24:27], s86 offen offset:1024 lds
    s_waitcnt vmcnt(19)
    s_barrier
    buffer_load_dwordx4 v6, s[24:27], s86 offen offset:2048 lds
    buffer_load_dwordx4 v7, s[24:27], s86 offen offset:3072 lds
    s_add_u32 m0, s87, 81920
    s_add_u32 s86, s92, 368640
    buffer_load_dwordx4 v22, s[44:47], s86 offen offset:0 sc1 lds
    s_mov_b32 s88, 32768
L_p2:
    s_waitcnt lgkmcnt(0)
    s_xor_b32 s82, s48, s78
    s_xor_b32 s83, s49, s78
    s_or_b32 s82, s82, s83
    s_xor_b32 s83, s50, s78
    s_or_b32 s82, s82, s83
    s_xor_b32 s83, s51, s78
    s_or_b32 s82, s82, s83
    s_xor_b32 s83, s52, s78
    s_or_b32 s82, s82, s83
    s_xor_b32 s83, s53, s78
    s_or_b32 s82, s82, s83
    s_xor_b32 s83, s54, s78
    s_or_b32 s82, s82, s83
    s_xor_b32 s83, s55, s78
    s_or_b32 s82, s82, s83
    s_cbranch_scc0 L_p2_ok
    s_buffer_load_dwordx4 s[48:51], s[44:47], s70 glc
    s_buffer_load_dwordx4 s[52:55], s[44:47], s70 offset:64 glc
    s_sub_u32 s88, s88, 1
    s_cbranch_scc0 L_p2
    s_waitcnt lgkmcnt(0)
L_p2_ok:
    buffer_load_dwordx4 v23, s[44:47], s86 offen offset:1024 sc1 lds
    buffer_load_dwordx4 v8, s[44:47], s86 offen offset:2048 sc1 lds
    s_add_u32 m0, s95, 0
    s_add_u32 s86, s91, 1920
    buffer_load_dwordx4 v4, s[24:27], s86 offen offset:0 lds
    buffer_load_dwordx4 v5, s[24:27], s86 offen offset:1024 lds
    s_waitcnt vmcnt(19)
    s_barrier
    buffer_load_dwordx4 v6, s[24:27], s86 offen offset:2048 lds
    buffer_load_dwordx4 v7, s[24:27], s86 offen offset:3072 lds
    s_mul_i32 s85, s77, 4096
    s_add_u32 m0, s85, 143360
    s_lshl_b32 s85, s85, 3
    s_add_u32 s86, s85, s90
    s_add_u32 s86, s86, 0
    buffer_load_dwordx4 v9, s[16:19], s86 offen offset:0 lds
    s_add_u32 s86, s86, 7168
    buffer_load_dwordx4 v9, s[16:19], s86 offen offset:1024 lds
    s_add_u32 s86, s86, 7168
    buffer_load_dwordx4 v9, s[16:19], s86 offen offset:2048 lds
    s_add_u32 s86, s86, 7168
    buffer_load_dwordx4 v9, s[16:19], s86 offen offset:3072 lds
    s_add_u32 m0, s95, 16384
    s_add_u32 s86, s89, 0
    buffer_load_dwordx4 v22, s[44:47], s86 offen offset:0 sc1 lds
    s_waitcnt vmcnt(19)
    s_barrier
    s_lshl3_add_u32 s82, s72, s73
    s_lshl_b32 s82, s82, 15
    s_add_u32 s82, s82, 0x1000000
    s_buffer_load_dword s7, s[44:47], s82 offset:1536
    buffer_load_dwordx4 v23, s[44:47], s86 offen offset:1024 sc1 lds
    buffer_load_dwordx4 v24, s[44:47], s86 offen offset:2048 sc1 lds
    buffer_load_dwordx4 v25, s[44:47], s86 offen offset:3072 sc1 lds
    s_mul_i32 s85, s77, 4096
    s_add_u32 m0, s85, 94208
    s_lshl_b32 s85, s85, 3
    s_add_u32 s86, s85, s90
    s_add_u32 s86, s86, 131072
    buffer_load_dwordx4 v9, s[16:19], s86 offen offset:0 lds
    s_add_u32 s86, s86, 7168
    buffer_load_dwordx4 v9, s[16:19], s86 offen offset:1024 lds
    s_waitcnt vmcnt(17)
    s_barrier
    s_add_u32 s86, s86, 7168
    buffer_load_dwordx4 v9, s[16:19], s86 offen offset:2048 lds
    s_add_u32 s86, s86, 7168
    buffer_load_dwordx4 v9, s[16:19], s86 offen offset:3072 lds
    s_add_u32 m0, s95, 32768
    s_add_u32 s86, s89, 32768
    buffer_load_dwordx4 v22, s[44:47], s86 offen offset:0 sc1 lds
    buffer_load_dwordx4 v23, s[44:47], s86 offen offset:1024 sc1 lds
    buffer_load_dwordx4 v24, s[44:47], s86 offen offset:2048 sc1 lds
    s_waitcnt vmcnt(15)
    s_barrier
    buffer_load_dwordx4 v25, s[44:47], s86 offen offset:3072 sc1 lds
    s_mul_i32 s85, s77, 4096
    s_add_u32 m0, s85, 110592
    s_lshl_b32 s85, s85, 3
    s_add_u32 s86, s85, s90
    s_add_u32 s86, s86, 262144
    buffer_load_dwordx4 v9, s[16:19], s86 offen offset:0 lds
    s_add_u32 s86, s86, 7168
    buffer_load_dwordx4 v9, s[16:19], s86 offen offset:1024 lds
    s_add_u32 s86, s86, 7168
    buffer_load_dwordx4 v9, s[16:19], s86 offen offset:2048 lds
    s_barrier
    s_add_u32 s86, s86, 7168
    buffer_load_dwordx4 v9, s[16:19], s86 offen offset:3072 lds
    s_add_u32 m0, s95, 49152
    s_add_u32 s86, s89, 65536
    buffer_load_dwordx4 v22, s[44:47], s86 offen offset:0 sc1 lds
    buffer_load_dwordx4 v23, s[44:47], s86 offen offset:1024 sc1 lds
    buffer_load_dwordx4 v24, s[44:47], s86 offen offset:2048 sc1 lds
    buffer_load_dwordx4 v25, s[44:47], s86 offen offset:3072 sc1 lds
    s_mul_i32 s85, s77, 4096
    s_add_u32 m0, s85, 126976
    s_lshl_b32 s85, s85, 3
    s_add_u32 s86, s85, s90
    s_add_u32 s86, s86, 393216
    buffer_load_dwordx4 v9, s[16:19], s86 offen offset:0 lds
    s_add_u32 s86, s86, 7168
    buffer_load_dwordx4 v9, s[16:19], s86 offen offset:1024 lds
    s_add_u32 s86, s86, 7168
    buffer_load_dwordx4 v9, s[16:19], s86 offen offset:2048 lds
    s_add_u32 s86, s86, 7168
    buffer_load_dwordx4 v9, s[16:19], s86 offen offset:3072 lds
    s_add_u32 m0, s95, 65536
    s_add_u32 s86, s89, 98304
    buffer_load_dwordx4 v22, s[44:47], s86 offen offset:0 sc1 lds
    buffer_load_dwordx4 v23, s[44:47], s86 offen offset:1024 sc1 lds
    buffer_load_dwordx4 v24, s[44:47], s86 offen offset:2048 sc1 lds
    buffer_load_dwordx4 v25, s[44:47], s86 offen offset:3072 sc1 lds
    s_mul_i32 s85, s77, 4096
    s_add_u32 m0, s85, 0
    s_lshl_b32 s85, s85, 3
    s_add_u32 s86, s85, s90
    s_add_u32 s86, s86, 0
    buffer_load_dwordx4 v9, s[32:35], s86 offen offset:0 lds
    s_add_u32 s86, s86, 7168
    buffer_load_dwordx4 v9, s[32:35], s86 offen offset:1024 lds
    s_add_u32 s86, s86, 7168
    buffer_load_dwordx4 v9, s[32:35], s86 offen offset:2048 lds
    s_add_u32 s86, s86, 7168
    buffer_load_dwordx4 v9, s[32:35], s86 offen offset:3072 lds
    s_mul_i32 s85, s77, 2048
    s_add_u32 m0, s85, 81920
    s_lshl_b32 s85, s85, 3
    s_add_u32 s86, s85, s90
    s_add_u32 s86, s86, 655360
    buffer_load_dwordx4 v9, s[32:35], s86 offen offset:0 lds
    s_add_u32 s86, s86, 7168
    buffer_load_dwordx4 v9, s[32:35], s86 offen offset:1024 lds
    s_mul_i32 s85, s80, 69632
    s_lshl_b32 s84, s79, 11
    s_add_u32 s85, s85, s84
    s_add_u32 m0, s85, 90112
    s_lshl_b32 s85, s77, 4
    s_add_u32 s85, s85, s81
    s_lshl_b32 s85, s85, 10
    s_add_u32 s86, s85, s90
    buffer_load_dwordx4 v9, s[8:11], s86 offen lds
    s_waitcnt vmcnt(31)
    s_barrier
    s_add_u32 s86, s86, 7168
    buffer_load_dwordx4 v9, s[8:11], s86 offen offset:1024 lds
    s_waitcnt vmcnt(24)
    s_barrier
    s_mul_i32 s85, s77, 4096
    s_add_u32 m0, s85, 143360
    s_lshl_b32 s85, s85, 3
    s_add_u32 s86, s85, s90
    s_add_u32 s86, s86, 131072
    buffer_load_dwordx4 v9, s[32:35], s86 offen offset:0 lds
    s_add_u32 s86, s86, 7168
    buffer_load_dwordx4 v9, s[32:35], s86 offen offset:1024 lds
    s_add_u32 s86, s86, 7168
    buffer_load_dwordx4 v9, s[32:35], s86 offen offset:2048 lds
    s_add_u32 s86, s86, 7168
    buffer_load_dwordx4 v9, s[32:35], s86 offen offset:3072 lds
    s_waitcnt vmcnt(20)
    s_barrier
    s_mul_i32 s85, s77, 4096
    s_add_u32 m0, s85, 94208
    s_lshl_b32 s85, s85, 3
    s_add_u32 s86, s85, s90
    s_add_u32 s86, s86, 262144
    buffer_load_dwordx4 v9, s[32:35], s86 offen offset:0 lds
    s_add_u32 s86, s86, 7168
    buffer_load_dwordx4 v9, s[32:35], s86 offen offset:1024 lds
    s_add_u32 s86, s86, 7168
    buffer_load_dwordx4 v9, s[32:35], s86 offen offset:2048 lds
    s_add_u32 s86, s86, 7168
    buffer_load_dwordx4 v9, s[32:35], s86 offen offset:3072 lds
    s_waitcnt vmcnt(16)
    s_barrier
    s_mul_i32 s85, s77, 4096
    s_add_u32 m0, s85, 110592
    s_lshl_b32 s85, s85, 3
    s_add_u32 s86, s85, s90
    s_add_u32 s86, s86, 393216
    buffer_load_dwordx4 v9, s[32:35], s86 offen offset:0 lds
    s_add_u32 s86, s86, 7168
    buffer_load_dwordx4 v9, s[32:35], s86 offen offset:1024 lds
    s_add_u32 s86, s86, 7168
    buffer_load_dwordx4 v9, s[32:35], s86 offen offset:2048 lds
    s_add_u32 s86, s86, 7168
    buffer_load_dwordx4 v9, s[32:35], s86 offen offset:3072 lds
    s_waitcnt vmcnt(16)
    s_barrier
    s_mul_i32 s85, s77, 4096
    s_add_u32 m0, s85, 126976
    s_lshl_b32 s85, s85, 3
    s_add_u32 s86, s85, s90
    s_add_u32 s86, s86, 524288
    buffer_load_dwordx4 v9, s[32:35], s86 offen offset:0 lds
    s_add_u32 s86, s86, 7168
    buffer_load_dwordx4 v9, s[32:35], s86 offen offset:1024 lds
    s_add_u32 s86, s86, 7168
    buffer_load_dwordx4 v9, s[32:35], s86 offen offset:2048 lds
    s_add_u32 s86, s86, 7168
    buffer_load_dwordx4 v9, s[32:35], s86 offen offset:3072 lds
    s_cmp_eq_u32 s77, 3
    s_cselect_b32 s82, 0x80000000, 0
    v_or_b32 v8, s82, v22
    v_or_b32 v16, s82, v23
    s_lshl_b32 s70, s72, 2
    s_add_u32 s70, s70, s77
    s_lshl_b32 s70, s70, 7
    s_add_u32 s70, s70, 0xb40000
    s_buffer_load_dwordx4 s[48:51], s[44:47], s70 glc
    s_buffer_load_dwordx4 s[52:55], s[44:47], s70 offset:64 glc
    s_waitcnt vmcnt(12)
    s_barrier
    s_waitcnt vmcnt(8)
    s_barrier
    s_mov_b32 s88, 32768
L_p3:
    s_waitcnt lgkmcnt(0)
    s_xor_b32 s82, s48, s78
    s_xor_b32 s83, s49, s78
    s_or_b32 s82, s82, s83
    s_xor_b32 s83, s50, s78
    s_or_b32 s82, s82, s83
    s_xor_b32 s83, s51, s78
    s_or_b32 s82, s82, s83
    s_xor_b32 s83, s52, s78
    s_or_b32 s82, s82, s83
    s_xor_b32 s83, s53, s78
    s_or_b32 s82, s82, s83
    s_xor_b32 s83, s54, s78
    s_or_b32 s82, s82, s83
    s_xor_b32 s83, s55, s78
    s_or_b32 s82, s82, s83
    s_cbranch_scc0 L_p3_ok
    s_buffer_load_dwordx4 s[48:51], s[44:47], s70 glc
    s_buffer_load_dwordx4 s[52:55], s[44:47], s70 offset:64 glc
    s_sub_u32 s88, s88, 1
    s_cbranch_scc0 L_p3
    s_waitcnt lgkmcnt(0)
L_p3_ok:
    s_waitcnt vmcnt(4)
    s_barrier
    s_add_u32 m0, s95, 16384
    s_add_u32 s86, s89, 131072
    buffer_load_dwordx4 v22, s[44:47], s86 offen offset:0 sc1 lds
    buffer_load_dwordx4 v23, s[44:47], s86 offen offset:1024 sc1 lds
    buffer_load_dwordx4 v24, s[44:47], s86 offen offset:2048 sc1 lds
    buffer_load_dwordx4 v25, s[44:47], s86 offen offset:3072 sc1 lds
    s_add_u32 m0, s95, 32768
    s_add_u32 s86, s89, 163840
    buffer_load_dwordx4 v22, s[44:47], s86 offen offset:0 sc1 lds
    buffer_load_dwordx4 v23, s[44:47], s86 offen offset:1024 sc1 lds
    buffer_load_dwordx4 v24, s[44:47], s86 offen offset:2048 sc1 lds
    buffer_load_dwordx4 v25, s[44:47], s86 offen offset:3072 sc1 lds
    s_add_u32 m0, s95, 49152
    s_add_u32 s86, s89, 196608
    buffer_load_dwordx4 v22, s[44:47], s86 offen offset:0 sc1 lds
    buffer_load_dwordx4 v23, s[44:47], s86 offen offset:1024 sc1 lds
    buffer_load_dwordx4 v24, s[44:47], s86 offen offset:2048 sc1 lds
    buffer_load_dwordx4 v25, s[44:47], s86 offen offset:3072 sc1 lds
    s_waitcnt vmcnt(8)
    s_barrier
    s_add_u32 m0, s95, 65536
    s_add_u32 s86, s89, 229376
    buffer_load_dwordx4 v22, s[44:47], s86 offen offset:0 sc1 lds
    buffer_load_dwordx4 v23, s[44:47], s86 offen offset:1024 sc1 lds
    buffer_load_dwordx4 v24, s[44:47], s86 offen offset:2048 sc1 lds
    buffer_load_dwordx4 v25, s[44:47], s86 offen offset:3072 sc1 lds
    s_waitcnt vmcnt(8)
    s_barrier
    s_add_u32 m0, s95, 0
    s_add_u32 s86, s89, 262144
    buffer_load_dwordx4 v22, s[44:47], s86 offen offset:0 sc1 lds
    buffer_load_dwordx4 v23, s[44:47], s86 offen offset:1024 sc1 lds
    buffer_load_dwordx4 v24, s[44:47], s86 offen offset:2048 sc1 lds
    buffer_load_dwordx4 v25, s[44:47], s86 offen offset:3072 sc1 lds
    s_waitcnt vmcnt(8)
    s_barrier
    s_lshr_b32 s85, s95, 1
    s_sub_u32 s86, s89, s95
    s_add_u32 m0, s85, 143360
    s_add_u32 s86, s86, 294912
    buffer_load_dwordx4 v8, s[44:47], s86 offen offset:0 sc1 lds
    buffer_load_dwordx4 v16, s[44:47], s86 offen offset:1024 sc1 lds
    s_waitcnt vmcnt(6)
    s_barrier
    s_waitcnt vmcnt(2)
    s_barrier
    s_waitcnt vmcnt(0)
    s_barrier
    s_or_b32 s82, s2, s76
    s_cmp_lg_u32 s82, 0
    s_cbranch_scc1 L_noreset
    v_mov_b32 v21, 0
    s_mov_b64 exec, 1
    buffer_store_dword v21, v21, s[40:43], 0 offen sc1
    s_mov_b64 exec, -1
L_noreset:
    s_endpgm
.p2align 12
L_g1:
L_pg3:
    s_cbranch_execz L_warmed
    s_barrier
    s_add_u32 m0, s87, 73728
    s_xor_b32 s85, s100, 3
    s_mul_i32 s85, s85, 352256
    s_add_u32 s86, s91, s85
    s_add_u32 s86, s86, 1376
    buffer_load_dwordx4 v37, s[20:23], s86 offen offset:0 lds
    buffer_load_dwordx4 v38, s[20:23], s86 offen offset:1024 lds
    buffer_load_dwordx4 v39, s[20:23], s86 offen offset:2048 lds
    s_add_u32 m0, s87, 76800
    s_add_u32 s86, s86, 44032
    buffer_load_dwordx4 v37, s[20:23], s86 offen offset:0 lds
    buffer_load_dwordx4 v38, s[20:23], s86 offen offset:1024 lds
    buffer_load_dwordx4 v39, s[20:23], s86 offen offset:2048 lds
    s_lshl_b32 s82, s77, 2
    s_add_u32 s82, s82, s81
    s_add_u32 s82, s82, -16
    v_add_u32 v6, s82, v2
    v_lshlrev_b32 v6, 10, v6
    v_lshl_add_u32 v6, v3, 4, v6
    buffer_load_dwordx4 v[8:11], v6, s[8:11], 0 offen offset:0
    buffer_load_dwordx4 v[12:15], v6, s[8:11], 0 offen offset:256
    buffer_load_dwordx4 v[16:19], v6, s[8:11], 0 offen offset:512
    buffer_load_dwordx4 v[20:23], v6, s[8:11], 0 offen offset:768
    s_lshl_b32 s82, s79, 5
    s_add_u32 s82, s82, s81
    s_lshl_b32 s82, s82, 1
    v_lshlrev_b32 v4, 2, v3
    buffer_load_dword v6, v4, s[28:31], s82 offen
    v_min_u32 v4, 11, v3
    v_lshrrev_b32 v5, 2, v4
    v_and_b32 v4, 3, v4
    v_lshlrev_b32 v4, 7, v4
    v_lshl_add_u32 v4, v5, 10, v4
    s_movk_i32 s82, 3072
    v_mad_u32_u24 v4, v2, s82, v4
    s_lshl_b32 s82, s96, 2
    s_add_u32 s82, s82, s77
    s_mul_i32 s82, s82, 12288
    s_lshl_b32 s83, s97, 9
    s_add_u32 s82, s82, s83
    s_bfe_u32 s83, s2, 0x20001
    s_lshl_b32 s83, s83, 4
    s_lshl_b64 exec, 0xffff, s83
    s_cmp_eq_u32 s97, 0
    s_cselect_b32 s83, 0x08880888, 0
    s_or_b32 exec_lo, exec_lo, s83
    s_or_b32 exec_hi, exec_hi, s83
    buffer_load_dword v255, v4, s[12:15], s82 offen
    s_mov_b64 exec, -1
    v_lshlrev_b32 v4, 7, v1
    s_cmp_ge_u32 s77, 2
    s_cbranch_scc1 L_u2
    s_cmp_eq_u32 s77, 1
    s_cbranch_scc1 L_u1
    s_lshl_b32 s82, s2, 11
    s_mov_b64 exec, 0xffff
    buffer_load_dword v255, v4, s[16:19], s82 offen
    s_branch L_u4
L_u1:
    s_mul_i32 s82, s2, 3072
    s_mov_b64 exec, 0xffffff
    buffer_load_dword v255, v4, s[32:35], s82 offen
    s_branch L_u4
L_u2:
    s_cmp_eq_u32 s77, 3
    s_cbranch_scc1 L_u3
    s_lshl_b32 s82, s81, 12
    s_mov_b64 exec, 1
    buffer_load_dword v255, v4, s[24:27], s82 offen
    s_branch L_u4
L_u3:
    v_lshlrev_b32 v4, 21, v1
    s_mov_b32 s82, 0x1fff80
    s_mov_b64 exec, 0x1ffff
    buffer_load_dword v255, v4, s[44:47], s82 offen
L_u4:
    s_mov_b64 exec, -1
    s_lshl_b32 s82, s77, 2
    v_add_u32 v36, s82, v2
    v_and_b32 v48, 1, v36
    v_xor_b32 v48, 1, v48
    v_lshrrev_b32 v36, 1, v36
    v_lshl_add_u32 v36, v48, 3, v36
    v_mov_b32 v35, 0x14000
    v_xor_b32 v48, v3, v36
    v_lshl_add_u32 v35, v36, 10, v35
    v_lshl_add_u32 v35, v48, 4, v35
    s_barrier
    s_mov_b32 s89, 0x3f803f80
    s_mov_b32 s90, 0xffff0000
    s_waitcnt vmcnt(6)
    v_lshlrev_b32 v48, 16, v8
    v_and_b32 v49, s90, v8
    v_lshlrev_b32 v50, 16, v9
    v_and_b32 v51, s90, v9
    v_lshlrev_b32 v52, 16, v10
    v_and_b32 v53, s90, v10
    v_lshlrev_b32 v54, 16, v11
    v_and_b32 v55, s90, v11
    s_waitcnt vmcnt(5)
    v_lshlrev_b32 v56, 16, v12
    v_and_b32 v57, s90, v12
    v_lshlrev_b32 v58, 16, v13
    v_and_b32 v59, s90, v13
    v_lshlrev_b32 v60, 16, v14
    v_and_b32 v61, s90, v14
    v_lshlrev_b32 v62, 16, v15
    v_and_b32 v63, s90, v15
    s_waitcnt vmcnt(4)
    v_lshlrev_b32 v64, 16, v16
    v_and_b32 v65, s90, v16
    v_lshlrev_b32 v66, 16, v17
    v_and_b32 v67, s90, v17
    v_lshlrev_b32 v68, 16, v18
    v_and_b32 v69, s90, v18
    v_lshlrev_b32 v70, 16, v19
    v_and_b32 v71, s90, v19
    s_waitcnt vmcnt(3)
    v_lshlrev_b32 v72, 16, v20
    v_and_b32 v73, s90, v20
    v_lshlrev_b32 v74, 16, v21
    v_and_b32 v75, s90, v21
    v_lshlrev_b32 v76, 16, v22
    v_and_b32 v77, s90, v22
    v_lshlrev_b32 v78, 16, v23
    v_and_b32 v79, s90, v23
    v_add_f32 v36, v48, v49
    v_mul_f32 v80, v48, v48
    v_fmac_f32 v80, v49, v49
    v_add_f32 v36, v36, v50
    v_fmac_f32 v80, v50, v50
    v_add_f32 v36, v36, v51
    v_fmac_f32 v80, v51, v51
    v_add_f32 v36, v36, v52
    v_fmac_f32 v80, v52, v52
    v_add_f32 v36, v36, v53
    v_fmac_f32 v80, v53, v53
    v_add_f32 v36, v36, v54
    v_fmac_f32 v80, v54, v54
    v_add_f32 v36, v36, v55
    v_fmac_f32 v80, v55, v55
    v_add_f32 v36, v36, v56
    s_barrier
    s_add_u32 m0, s87, 0
    s_xor_b32 s85, s100, 0
    s_mul_i32 s85, s85, 352256
    s_add_u32 s86, s91, s85
    buffer_load_dwordx4 v37, s[20:23], s86 offen offset:0 lds
    v_fmac_f32 v80, v56, v56
    v_add_f32 v36, v36, v57
    v_fmac_f32 v80, v57, v57
    v_add_f32 v36, v36, v58
    v_fmac_f32 v80, v58, v58
    v_add_f32 v36, v36, v59
    v_fmac_f32 v80, v59, v59
    v_add_f32 v36, v36, v60
    v_fmac_f32 v80, v60, v60
    v_add_f32 v36, v36, v61
    buffer_load_dwordx4 v38, s[20:23], s86 offen offset:1024 lds
    v_fmac_f32 v80, v61, v61
    v_add_f32 v36, v36, v62
    v_fmac_f32 v80, v62, v62
    v_add_f32 v36, v36, v63
    v_fmac_f32 v80, v63, v63
    v_add_f32 v36, v36, v64
    v_fmac_f32 v80, v64, v64
    v_add_f32 v36, v36, v65
    v_fmac_f32 v80, v65, v65
    v_add_f32 v36, v36, v66
    buffer_load_dwordx4 v39, s[20:23], s86 offen offset:2048 lds
    v_fmac_f32 v80, v66, v66
    v_add_f32 v36, v36, v67
    v_fmac_f32 v80, v67, v67
    v_add_f32 v36, v36, v68
    v_fmac_f32 v80, v68, v68
    v_add_f32 v36, v36, v69
    v_fmac_f32 v80, v69, v69
    v_add_f32 v36, v36, v70
    v_fmac_f32 v80, v70, v70
    v_add_f32 v36, v36, v71
    s_add_u32 m0, s87, 3072
    s_add_u32 s86, s86, 44032
    buffer_load_dwordx4 v37, s[20:23], s86 offen offset:0 lds
    v_fmac_f32 v80, v71, v71
    v_add_f32 v36, v36, v72
    v_fmac_f32 v80, v72, v72
    v_add_f32 v36, v36, v73
    v_fmac_f32 v80, v73, v73
    v_add_f32 v36, v36, v74
    v_fmac_f32 v80, v74, v74
    v_add_f32 v36, v36, v75
    v_fmac_f32 v80, v75, v75
    v_add_f32 v36, v36, v76
    buffer_load_dwordx4 v38, s[20:23], s86 offen offset:1024 lds
    v_fmac_f32 v80, v76, v76
    v_add_f32 v36, v36, v77
    v_fmac_f32 v80, v77, v77
    v_add_f32 v36, v36, v78
    v_fmac_f32 v80, v78, v78
    v_add_f32 v36, v36, v79
    v_fmac_f32 v80, v79, v79
    s_nop 0
    v_add_f32_dpp v36, v36, v36 row_ror:8 row_mask:0xf bank_mask:0xf
    v_add_f32_dpp v80, v80, v80 row_ror:8 row_mask:0xf bank_mask:0xf
    s_nop 0
    v_add_f32_dpp v36, v36, v36 row_ror:4 row_mask:0xf bank_mask:0xf
    buffer_load_dwordx4 v39, s[20:23], s86 offen offset:2048 lds
    v_add_f32_dpp v80, v80, v80 row_ror:4 row_mask:0xf bank_mask:0xf
    v_add_f32_dpp v36, v36, v36 row_ror:2 row_mask:0xf bank_mask:0xf
    s_nop 0
    v_add_f32_dpp v80, v80, v80 row_ror:2 row_mask:0xf bank_mask:0xf
    v_add_f32_dpp v36, v36, v36 row_ror:1 row_mask:0xf bank_mask:0xf
    s_nop 0
    v_add_f32_dpp v80, v80, v80 row_ror:1 row_mask:0xf bank_mask:0xf
    v_mul_f32 v36, 0x3b000000, v36
    v_mul_f32 v80, 0x3b000000, v80
    v_fma_f32 v80, -v36, v36, v80
    v_max_f32 v80, 0, v80
    v_add_f32 v80, 0x3727c5ac, v80
    v_rsq_f32 v82, v80
    s_nop 0
    v_mul_f32 v83, -v36, v82
    v_fma_f32 v48, v48, v82, v83
    v_fma_f32 v49, v49, v82, v83
    v_fma_f32 v50, v50, v82, v83
    v_fma_f32 v51, v51, v82, v83
    v_fma_f32 v52, v52, v82, v83
    v_fma_f32 v53, v53, v82, v83
    v_fma_f32 v54, v54, v82, v83
    v_fma_f32 v55, v55, v82, v83
    s_barrier
    s_setprio 3
    s_add_u32 m0, s87, 24576
    s_xor_b32 s85, s100, 1
    s_mul_i32 s85, s85, 352256
    s_add_u32 s86, s91, s85
    buffer_load_dwordx4 v37, s[20:23], s86 offen offset:0 lds
    v_cvt_pk_bf16_f32 v8, v48, v49
    v_cvt_pk_bf16_f32 v9, v50, v51
    v_cvt_pk_bf16_f32 v10, v52, v53
    v_cvt_pk_bf16_f32 v11, v54, v55
    v_fma_f32 v56, v56, v82, v83
    v_fma_f32 v57, v57, v82, v83
    v_fma_f32 v58, v58, v82, v83
    v_fma_f32 v59, v59, v82, v83
    buffer_load_dwordx4 v38, s[20:23], s86 offen offset:1024 lds
    v_fma_f32 v60, v60, v82, v83
    v_fma_f32 v61, v61, v82, v83
    v_fma_f32 v62, v62, v82, v83
    v_fma_f32 v63, v63, v82, v83
    v_cvt_pk_bf16_f32 v12, v56, v57
    v_cvt_pk_bf16_f32 v13, v58, v59
    v_cvt_pk_bf16_f32 v14, v60, v61
    v_cvt_pk_bf16_f32 v15, v62, v63
    buffer_load_dwordx4 v39, s[20:23], s86 offen offset:2048 lds
    v_fma_f32 v64, v64, v82, v83
    v_fma_f32 v65, v65, v82, v83
    v_fma_f32 v66, v66, v82, v83
    v_fma_f32 v67, v67, v82, v83
    v_fma_f32 v68, v68, v82, v83
    v_fma_f32 v69, v69, v82, v83
    v_fma_f32 v70, v70, v82, v83
    v_fma_f32 v71, v71, v82, v83
    s_add_u32 m0, s87, 27648
    s_add_u32 s86, s86, 44032
    buffer_load_dwordx4 v37, s[20:23], s86 offen offset:0 lds
    v_cvt_pk_bf16_f32 v16, v64, v65
    v_cvt_pk_bf16_f32 v17, v66, v67
    v_cvt_pk_bf16_f32 v18, v68, v69
    v_cvt_pk_bf16_f32 v19, v70, v71
    v_fma_f32 v72, v72, v82, v83
    v_fma_f32 v73, v73, v82, v83
    v_fma_f32 v74, v74, v82, v83
    v_fma_f32 v75, v75, v82, v83
    buffer_load_dwordx4 v38, s[20:23], s86 offen offset:1024 lds
    v_fma_f32 v76, v76, v82, v83
    v_fma_f32 v77, v77, v82, v83
    v_fma_f32 v78, v78, v82, v83
    v_fma_f32 v79, v79, v82, v83
    v_cvt_pk_bf16_f32 v20, v72, v73
    v_cvt_pk_bf16_f32 v21, v74, v75
    v_cvt_pk_bf16_f32 v22, v76, v77
    v_cvt_pk_bf16_f32 v23, v78, v79
    buffer_load_dwordx4 v39, s[20:23], s86 offen offset:2048 lds
    v_xor_b32 v40, v2, v3
    v_lshlrev_b32 v40, 4, v40
    v_lshl_add_u32 v40, v3, 10, v40
    s_lshl_b32 s82, s79, 15
    s_add_u32 s82, s82, 0x18000
    v_add_u32 v40, s82, v40
    v_xor_b32 v41, 64, v40
    v_xor_b32 v42, 128, v40
    v_xor_b32 v43, 192, v40
    v_and_b32 v46, 1, v2
    v_lshrrev_b32 v47, 2, v3
    v_lshl_add_u32 v47, v2, 3, v47
    v_mul_u32_u24 v44, 192, v47
    v_and_b32 v47, 3, v3
    v_lshl_add_u32 v44, v47, 3, v44
    s_mul_i32 s82, s80, 3
    s_add_u32 s83, s82, 1
    v_xor_b32 v47, s83, v46
    v_lshl_add_u32 v45, v47, 5, v44
    v_xor_b32 v47, s82, v46
    v_lshl_add_u32 v44, v47, 5, v44
    v_add_u32 v46, 6144, v44
    v_add_u32 v47, 6144, v45
    ds_write_b128 v35, v[8:11] offset:0
    ds_write_b128 v35, v[12:15] offset:256
    ds_write_b128 v35, v[16:19] offset:512
    ds_write_b128 v35, v[20:23] offset:768
    s_setprio 1
    v_mov_b32 v36, 73728
    s_waitcnt lgkmcnt(0)
    s_waitcnt vmcnt(6)
    s_barrier
    ds_read_b64_tr_b16 v[112:113], v44 offset:0
    ds_read_b64_tr_b16 v[114:115], v44 offset:768
    ds_read_b64_tr_b16 v[116:117], v45 offset:0
    ds_read_b64_tr_b16 v[118:119], v45 offset:768
    ds_read_b64_tr_b16 v[120:121], v44 offset:64
    ds_read_b64_tr_b16 v[122:123], v44 offset:832
    v_xor_b32 v40, s101, v40
    ds_read_b128 v[104:107], v40 offset:0
    ds_read_b128 v[108:111], v40 offset:16384
    ds_read_b64_tr_b16 v[132:133], v46 offset:0
    ds_read_b64_tr_b16 v[134:135], v46 offset:768
    ds_read_b64_tr_b16 v[136:137], v47 offset:0
    ds_read_b64_tr_b16 v[138:139], v47 offset:768
    ds_read_b64_tr_b16 v[140:141], v46 offset:64
    ds_read_b64_tr_b16 v[142:143], v46 offset:832
    v_xor_b32 v41, s101, v41
    ds_read_b128 v[124:127], v41 offset:0
    ds_read_b128 v[128:131], v41 offset:16384
    ds_read_b32 v36, v36
    s_waitcnt lgkmcnt(9)
    v_mfma_f32_16x16x32_bf16 v[8:11], v[112:115], v[104:107], 0
    ds_read_b64_tr_b16 v[152:153], v44 offset:12288
    ds_read_b64_tr_b16 v[154:155], v44 offset:13056
    v_mfma_f32_16x16x32_bf16 v[20:23], v[112:115], v[108:111], 0
    ds_read_b64_tr_b16 v[156:157], v45 offset:12288
    v_mfma_f32_16x16x32_bf16 v[12:15], v[116:119], v[104:107], 0
    ds_read_b64_tr_b16 v[158:159], v45 offset:13056
    ds_read_b64_tr_b16 v[160:161], v44 offset:12352
    v_mfma_f32_16x16x32_bf16 v[48:51], v[116:119], v[108:111], 0
    ds_read_b64_tr_b16 v[162:163], v44 offset:13120
    v_mfma_f32_16x16x32_bf16 v[16:19], v[120:123], v[104:107], 0
    v_xor_b32 v42, s101, v42
    ds_read_b128 v[144:147], v42 offset:0
    v_mfma_f32_16x16x32_bf16 v[52:55], v[120:123], v[108:111], 0
    ds_read_b128 v[148:151], v42 offset:16384
    s_waitcnt lgkmcnt(9)
    v_mfma_f32_16x16x32_bf16 v[8:11], v[132:135], v[124:127], v[8:11]
    ds_read_b64_tr_b16 v[112:113], v46 offset:12288
    ds_read_b64_tr_b16 v[114:115], v46 offset:13056
    v_mfma_f32_16x16x32_bf16 v[20:23], v[132:135], v[128:131], v[20:23]
    ds_read_b64_tr_b16 v[116:117], v47 offset:12288
    v_mfma_f32_16x16x32_bf16 v[12:15], v[136:139], v[124:127], v[12:15]
    ds_read_b64_tr_b16 v[118:119], v47 offset:13056
    ds_read_b64_tr_b16 v[120:121], v46 offset:12352
    v_mfma_f32_16x16x32_bf16 v[48:51], v[136:139], v[128:131], v[48:51]
    ds_read_b64_tr_b16 v[122:123], v46 offset:13120
    v_mfma_f32_16x16x32_bf16 v[16:19], v[140:143], v[124:127], v[16:19]
    v_xor_b32 v43, s101, v43
    ds_read_b128 v[104:107], v43 offset:0
    v_mfma_f32_16x16x32_bf16 v[52:55], v[140:143], v[128:131], v[52:55]
    ds_read_b128 v[108:111], v43 offset:16384
    s_waitcnt lgkmcnt(2)
    s_waitcnt vmcnt(0)
    s_barrier
    v_mfma_f32_16x16x32_bf16 v[8:11], v[152:155], v[144:147], v[8:11]
    ds_read_b64_tr_b16 v[132:133], v44 offset:24576
    ds_read_b64_tr_b16 v[134:135], v44 offset:25344
    ds_read_b64_tr_b16 v[136:137], v45 offset:24576
    v_mfma_f32_16x16x32_bf16 v[20:23], v[152:155], v[148:151], v[20:23]
    ds_read_b64_tr_b16 v[138:139], v45 offset:25344
    ds_read_b64_tr_b16 v[140:141], v44 offset:24640
    ds_read_b64_tr_b16 v[142:143], v44 offset:25408
    v_mfma_f32_16x16x32_bf16 v[12:15], v[156:159], v[144:147], v[12:15]
    v_xor_b32 v40, 256, v40
    ds_read_b128 v[124:127], v40 offset:0
    ds_read_b128 v[128:131], v40 offset:16384
    v_mfma_f32_16x16x32_bf16 v[48:51], v[156:159], v[148:151], v[48:51]
    v_xor_b32 v26, v2, v3
    v_lshlrev_b32 v26, 4, v26
    v_lshl_add_u32 v26, v3, 10, v26
    v_mfma_f32_16x16x32_bf16 v[16:19], v[160:163], v[144:147], v[16:19]
    s_mov_b32 s82, 0x18000
    v_add_u32 v26, s82, v26
    v_xor_b32 v27, 64, v26
    v_mfma_f32_16x16x32_bf16 v[52:55], v[160:163], v[148:151], v[52:55]
    v_xor_b32 v28, 128, v26
    v_xor_b32 v29, 192, v26
    v_subrev_u32 v30, 16384, v26
    s_waitcnt lgkmcnt(8)
    v_mfma_f32_16x16x32_bf16 v[8:11], v[112:115], v[104:107], v[8:11]
    ds_read_b64_tr_b16 v[152:153], v46 offset:24576
    ds_read_b64_tr_b16 v[154:155], v46 offset:25344
    v_mfma_f32_16x16x32_bf16 v[20:23], v[112:115], v[108:111], v[20:23]
    ds_read_b64_tr_b16 v[156:157], v47 offset:24576
    v_mfma_f32_16x16x32_bf16 v[12:15], v[116:119], v[104:107], v[12:15]
    ds_read_b64_tr_b16 v[158:159], v47 offset:25344
    ds_read_b64_tr_b16 v[160:161], v46 offset:24640
    v_mfma_f32_16x16x32_bf16 v[48:51], v[116:119], v[108:111], v[48:51]
    ds_read_b64_tr_b16 v[162:163], v46 offset:25408
    v_mfma_f32_16x16x32_bf16 v[16:19], v[120:123], v[104:107], v[16:19]
    v_xor_b32 v41, 256, v41
    ds_read_b128 v[144:147], v41 offset:0
    v_mfma_f32_16x16x32_bf16 v[52:55], v[120:123], v[108:111], v[52:55]
    ds_read_b128 v[148:151], v41 offset:16384
    s_waitcnt lgkmcnt(8)
    v_mfma_f32_16x16x32_bf16 v[8:11], v[132:135], v[124:127], v[8:11]
    ds_read_b64_tr_b16 v[112:113], v44 offset:36864
    ds_read_b64_tr_b16 v[114:115], v44 offset:37632
    v_mfma_f32_16x16x32_bf16 v[20:23], v[132:135], v[128:131], v[20:23]
    ds_read_b64_tr_b16 v[116:117], v45 offset:36864
    v_mfma_f32_16x16x32_bf16 v[12:15], v[136:139], v[124:127], v[12:15]
    ds_read_b64_tr_b16 v[118:119], v45 offset:37632
    ds_read_b64_tr_b16 v[120:121], v44 offset:36928
    v_mfma_f32_16x16x32_bf16 v[48:51], v[136:139], v[128:131], v[48:51]
    ds_read_b64_tr_b16 v[122:123], v44 offset:37696
    v_mfma_f32_16x16x32_bf16 v[16:19], v[140:143], v[124:127], v[16:19]
    v_xor_b32 v42, 256, v42
    ds_read_b128 v[104:107], v42 offset:0
    v_mfma_f32_16x16x32_bf16 v[52:55], v[140:143], v[128:131], v[52:55]
    ds_read_b128 v[108:111], v42 offset:16384
    s_waitcnt lgkmcnt(8)
    v_mfma_f32_16x16x32_bf16 v[8:11], v[152:155], v[144:147], v[8:11]
    ds_read_b64_tr_b16 v[132:133], v46 offset:36864
    ds_read_b64_tr_b16 v[134:135], v46 offset:37632
    v_mfma_f32_16x16x32_bf16 v[20:23], v[152:155], v[148:151], v[20:23]
    ds_read_b64_tr_b16 v[136:137], v47 offset:36864
    v_mfma_f32_16x16x32_bf16 v[12:15], v[156:159], v[144:147], v[12:15]
    ds_read_b64_tr_b16 v[138:139], v47 offset:37632
    ds_read_b64_tr_b16 v[140:141], v46 offset:36928
    v_mfma_f32_16x16x32_bf16 v[48:51], v[156:159], v[148:151], v[48:51]
    ds_read_b64_tr_b16 v[142:143], v46 offset:37696
    v_mfma_f32_16x16x32_bf16 v[16:19], v[160:163], v[144:147], v[16:19]
    v_xor_b32 v43, 256, v43
    ds_read_b128 v[124:127], v43 offset:0
    v_mfma_f32_16x16x32_bf16 v[52:55], v[160:163], v[148:151], v[52:55]
    ds_read_b128 v[128:131], v43 offset:16384
    s_waitcnt lgkmcnt(2)
    s_barrier
    v_mfma_f32_16x16x32_bf16 v[8:11], v[112:115], v[104:107], v[8:11]
    ds_read_b64_tr_b16 v[152:153], v44 offset:49152
    ds_read_b64_tr_b16 v[154:155], v44 offset:49920
    ds_read_b64_tr_b16 v[156:157], v45 offset:49152
    v_mfma_f32_16x16x32_bf16 v[20:23], v[112:115], v[108:111], v[20:23]
    ds_read_b64_tr_b16 v[158:159], v45 offset:49920
    ds_read_b64_tr_b16 v[160:161], v44 offset:49216
    ds_read_b64_tr_b16 v[162:163], v44 offset:49984
    v_mfma_f32_16x16x32_bf16 v[12:15], v[116:119], v[104:107], v[12:15]
    v_xor_b32 v40, 768, v40
    ds_read_b128 v[144:147], v40 offset:0
    ds_read_b128 v[148:151], v40 offset:16384
    v_mfma_f32_16x16x32_bf16 v[48:51], v[116:119], v[108:111], v[48:51]
    v_subrev_u32 v31, 16384, v27
    v_subrev_u32 v32, 16384, v28
    v_subrev_u32 v33, 16384, v29
    v_mfma_f32_16x16x32_bf16 v[16:19], v[120:123], v[104:107], v[16:19]
    v_and_b32 v4, 1, v2
    v_lshrrev_b32 v5, 2, v3
    v_lshl_add_u32 v34, v4, 2, v5
    v_mfma_f32_16x16x32_bf16 v[52:55], v[120:123], v[108:111], v[52:55]
    v_lshrrev_b32 v4, 1, v34
    v_xor_b32 v4, s77, v4
    v_lshlrev_b32 v4, 5, v4
    s_waitcnt lgkmcnt(8)
    v_mfma_f32_16x16x32_bf16 v[8:11], v[132:135], v[124:127], v[8:11]
    ds_read_b64_tr_b16 v[112:113], v46 offset:49152
    ds_read_b64_tr_b16 v[114:115], v46 offset:49920
    v_mfma_f32_16x16x32_bf16 v[20:23], v[132:135], v[128:131], v[20:23]
    ds_read_b64_tr_b16 v[116:117], v47 offset:49152
    v_mfma_f32_16x16x32_bf16 v[12:15], v[136:139], v[124:127], v[12:15]
    ds_read_b64_tr_b16 v[118:119], v47 offset:49920
    ds_read_b64_tr_b16 v[120:121], v46 offset:49216
    v_mfma_f32_16x16x32_bf16 v[48:51], v[136:139], v[128:131], v[48:51]
    ds_read_b64_tr_b16 v[122:123], v46 offset:49984
    v_mfma_f32_16x16x32_bf16 v[16:19], v[140:143], v[124:127], v[16:19]
    v_xor_b32 v41, 768, v41
    ds_read_b128 v[104:107], v41 offset:0
    v_mfma_f32_16x16x32_bf16 v[52:55], v[140:143], v[128:131], v[52:55]
    ds_read_b128 v[108:111], v41 offset:16384
    s_waitcnt lgkmcnt(8)
    v_mfma_f32_16x16x32_bf16 v[8:11], v[152:155], v[144:147], v[8:11]
    ds_read_b64_tr_b16 v[132:133], v44 offset:61440
    ds_read_b64_tr_b16 v[134:135], v44 offset:62208
    v_mfma_f32_16x16x32_bf16 v[20:23], v[152:155], v[148:151], v[20:23]
    ds_read_b64_tr_b16 v[136:137], v45 offset:61440
    v_mfma_f32_16x16x32_bf16 v[12:15], v[156:159], v[144:147], v[12:15]
    ds_read_b64_tr_b16 v[138:139], v45 offset:62208
    ds_read_b64_tr_b16 v[140:141], v44 offset:61504
    v_mfma_f32_16x16x32_bf16 v[48:51], v[156:159], v[148:151], v[48:51]
    ds_read_b64_tr_b16 v[142:143], v44 offset:62272
    v_mfma_f32_16x16x32_bf16 v[16:19], v[160:163], v[144:147], v[16:19]
    v_xor_b32 v42, 768, v42
    ds_read_b128 v[124:127], v42 offset:0
    v_mfma_f32_16x16x32_bf16 v[52:55], v[160:163], v[148:151], v[52:55]
    ds_read_b128 v[128:131], v42 offset:16384
    s_waitcnt lgkmcnt(8)
    v_mfma_f32_16x16x32_bf16 v[8:11], v[112:115], v[104:107], v[8:11]
    ds_read_b64_tr_b16 v[152:153], v46 offset:61440
    ds_read_b64_tr_b16 v[154:155], v46 offset:62208
    v_mfma_f32_16x16x32_bf16 v[20:23], v[112:115], v[108:111], v[20:23]
    ds_read_b64_tr_b16 v[156:157], v47 offset:61440
    v_mfma_f32_16x16x32_bf16 v[12:15], v[116:119], v[104:107], v[12:15]
    ds_read_b64_tr_b16 v[158:159], v47 offset:62208
    ds_read_b64_tr_b16 v[160:161], v46 offset:61504
    v_mfma_f32_16x16x32_bf16 v[48:51], v[116:119], v[108:111], v[48:51]
    ds_read_b64_tr_b16 v[162:163], v46 offset:62272
    v_mfma_f32_16x16x32_bf16 v[16:19], v[120:123], v[104:107], v[16:19]
    v_xor_b32 v43, 768, v43
    ds_read_b128 v[144:147], v43 offset:0
    v_mfma_f32_16x16x32_bf16 v[52:55], v[120:123], v[108:111], v[52:55]
    ds_read_b128 v[148:151], v43 offset:16384
    s_waitcnt lgkmcnt(2)
    s_barrier
    v_mfma_f32_16x16x32_bf16 v[8:11], v[132:135], v[124:127], v[8:11]
    ds_read_b64_tr_b16 v[112:113], v44 offset:0
    ds_read_b64_tr_b16 v[114:115], v44 offset:768
    ds_read_b64_tr_b16 v[116:117], v45 offset:0
    v_mfma_f32_16x16x32_bf16 v[20:23], v[132:135], v[128:131], v[20:23]
    ds_read_b64_tr_b16 v[118:119], v45 offset:768
    ds_read_b64_tr_b16 v[120:121], v44 offset:64
    ds_read_b64_tr_b16 v[122:123], v44 offset:832
    v_mfma_f32_16x16x32_bf16 v[12:15], v[136:139], v[124:127], v[12:15]
    v_xor_b32 v40, 256, v40
    ds_read_b128 v[104:107], v40 offset:0
    v_mfma_f32_16x16x32_bf16 v[48:51], v[136:139], v[128:131], v[48:51]
    ds_read_b128 v[108:111], v40 offset:16384
    v_lshl_add_u32 v4, v34, 7, v4
    v_and_b32 v5, 3, v3
    v_mfma_f32_16x16x32_bf16 v[16:19], v[140:143], v[124:127], v[16:19]
    v_lshl_add_u32 v4, v5, 3, v4
    v_lshrrev_b32 v5, 1, v2
    v_mul_u32_u24 v5, 6144, v5
    v_mfma_f32_16x16x32_bf16 v[52:55], v[140:143], v[128:131], v[52:55]
    v_add_u32 v24, v4, v5
    v_add_u32 v25, 12288, v24
    s_waitcnt lgkmcnt(8)
    v_mfma_f32_16x16x32_bf16 v[8:11], v[152:155], v[144:147], v[8:11]
    ds_read_b64_tr_b16 v[132:133], v46 offset:0
    ds_read_b64_tr_b16 v[134:135], v46 offset:768
    v_mfma_f32_16x16x32_bf16 v[20:23], v[152:155], v[148:151], v[20:23]
    ds_read_b64_tr_b16 v[136:137], v47 offset:0
    v_mfma_f32_16x16x32_bf16 v[12:15], v[156:159], v[144:147], v[12:15]
    ds_read_b64_tr_b16 v[138:139], v47 offset:768
    ds_read_b64_tr_b16 v[140:141], v46 offset:64
    v_mfma_f32_16x16x32_bf16 v[48:51], v[156:159], v[148:151], v[48:51]
    ds_read_b64_tr_b16 v[142:143], v46 offset:832
    v_mfma_f32_16x16x32_bf16 v[16:19], v[160:163], v[144:147], v[16:19]
    v_xor_b32 v41, 256, v41
    ds_read_b128 v[124:127], v41 offset:0
    v_mfma_f32_16x16x32_bf16 v[52:55], v[160:163], v[148:151], v[52:55]
    ds_read_b128 v[128:131], v41 offset:16384
    s_waitcnt lgkmcnt(8)
    v_mfma_f32_16x16x32_bf16 v[8:11], v[112:115], v[104:107], v[8:11]
    ds_read_b64_tr_b16 v[152:153], v44 offset:12288
    ds_read_b64_tr_b16 v[154:155], v44 offset:13056
    v_mfma_f32_16x16x32_bf16 v[20:23], v[112:115], v[108:111], v[20:23]
    ds_read_b64_tr_b16 v[156:157], v45 offset:12288
    v_mfma_f32_16x16x32_bf16 v[12:15], v[116:119], v[104:107], v[12:15]
    ds_read_b64_tr_b16 v[158:159], v45 offset:13056
    ds_read_b64_tr_b16 v[160:161], v44 offset:12352
    v_mfma_f32_16x16x32_bf16 v[48:51], v[116:119], v[108:111], v[48:51]
    ds_read_b64_tr_b16 v[162:163], v44 offset:13120
    v_mfma_f32_16x16x32_bf16 v[16:19], v[120:123], v[104:107], v[16:19]
    v_xor_b32 v42, 256, v42
    ds_read_b128 v[144:147], v42 offset:0
    v_mfma_f32_16x16x32_bf16 v[52:55], v[120:123], v[108:111], v[52:55]
    ds_read_b128 v[148:151], v42 offset:16384
    s_waitcnt lgkmcnt(8)
    v_mfma_f32_16x16x32_bf16 v[8:11], v[132:135], v[124:127], v[8:11]
    ds_read_b64_tr_b16 v[112:113], v46 offset:12288
    ds_read_b64_tr_b16 v[114:115], v46 offset:13056
    v_mfma_f32_16x16x32_bf16 v[20:23], v[132:135], v[128:131], v[20:23]
    ds_read_b64_tr_b16 v[116:117], v47 offset:12288
    v_mfma_f32_16x16x32_bf16 v[12:15], v[136:139], v[124:127], v[12:15]
    ds_read_b64_tr_b16 v[118:119], v47 offset:13056
    ds_read_b64_tr_b16 v[120:121], v46 offset:12352
    v_mfma_f32_16x16x32_bf16 v[48:51], v[136:139], v[128:131], v[48:51]
    ds_read_b64_tr_b16 v[122:123], v46 offset:13120
    v_mfma_f32_16x16x32_bf16 v[16:19], v[140:143], v[124:127], v[16:19]
    v_xor_b32 v43, 256, v43
    ds_read_b128 v[104:107], v43 offset:0
    v_mfma_f32_16x16x32_bf16 v[52:55], v[140:143], v[128:131], v[52:55]
    ds_read_b128 v[108:111], v43 offset:16384
    s_waitcnt lgkmcnt(2)
    s_barrier
    v_mfma_f32_16x16x32_bf16 v[8:11], v[152:155], v[144:147], v[8:11]
    ds_read_b64_tr_b16 v[92:93], v24 offset:24576
    v_mfma_f32_16x16x32_bf16 v[20:23], v[152:155], v[148:151], v[20:23]
    ds_read_b64_tr_b16 v[94:95], v24 offset:27648
    v_mfma_f32_16x16x32_bf16 v[12:15], v[156:159], v[144:147], v[12:15]
    ds_read_b64_tr_b16 v[96:97], v24 offset:25600
    v_mfma_f32_16x16x32_bf16 v[48:51], v[156:159], v[148:151], v[48:51]
    ds_read_b64_tr_b16 v[98:99], v24 offset:28672
    v_mfma_f32_16x16x32_bf16 v[16:19], v[160:163], v[144:147], v[16:19]
    ds_read_b64_tr_b16 v[100:101], v24 offset:26624
    v_mfma_f32_16x16x32_bf16 v[52:55], v[160:163], v[148:151], v[52:55]
    ds_read_b64_tr_b16 v[102:103], v24 offset:29696
    s_waitcnt lgkmcnt(6)
    v_mfma_f32_16x16x32_bf16 v[8:11], v[112:115], v[104:107], v[8:11]
    ds_read_b128 v[76:79], v26 offset:0
    v_mfma_f32_16x16x32_bf16 v[20:23], v[112:115], v[108:111], v[20:23]
    ds_read_b128 v[80:83], v26 offset:16384
    v_mfma_f32_16x16x32_bf16 v[12:15], v[116:119], v[104:107], v[12:15]
    ds_read_b128 v[84:87], v26 offset:32768
    v_mfma_f32_16x16x32_bf16 v[48:51], v[116:119], v[108:111], v[48:51]
    ds_read_b128 v[88:91], v26 offset:49152
    v_mfma_f32_16x16x32_bf16 v[16:19], v[120:123], v[104:107], v[16:19]
    ds_read_b128 v[72:75], v30 offset:0
    v_mfma_f32_16x16x32_bf16 v[52:55], v[120:123], v[108:111], v[52:55]
    v_readfirstlane_b32 s78, v36
    s_waitcnt lgkmcnt(3)
    v_mfma_f32_16x16x32_bf16 v[56:59], v[92:95], v[76:79], 0
    ds_read_b64_tr_b16 v[152:153], v25 offset:24576
    v_mfma_f32_16x16x32_bf16 v[40:43], v[96:99], v[76:79], 0
    ds_read_b64_tr_b16 v[154:155], v25 offset:27648
    v_mfma_f32_16x16x32_bf16 v[116:119], v[76:79], v[100:103], 0
    ds_read_b64_tr_b16 v[156:157], v25 offset:25600
    v_mfma_f32_16x16x32_bf16 v[60:63], v[92:95], v[80:83], 0
L_pg4:
    s_cbranch_execz L_warmed
    ds_read_b64_tr_b16 v[158:159], v25 offset:28672
    v_mfma_f32_16x16x32_bf16 v[44:47], v[96:99], v[80:83], 0
    ds_read_b64_tr_b16 v[160:161], v25 offset:26624
    v_mfma_f32_16x16x32_bf16 v[120:123], v[80:83], v[100:103], 0
    ds_read_b64_tr_b16 v[162:163], v25 offset:29696
    s_waitcnt lgkmcnt(6)
    ds_read_b128 v[136:139], v27 offset:0
    v_mfma_f32_16x16x32_bf16 v[64:67], v[92:95], v[84:87], 0
    ds_read_b128 v[140:143], v27 offset:16384
    v_mfma_f32_16x16x32_bf16 v[104:107], v[96:99], v[84:87], 0
    ds_read_b128 v[144:147], v27 offset:32768
    v_mfma_f32_16x16x32_bf16 v[124:127], v[84:87], v[100:103], 0
    ds_read_b128 v[148:151], v27 offset:49152
    v_mfma_f32_16x16x32_bf16 v[68:71], v[92:95], v[88:91], 0
    ds_read_b128 v[132:135], v31 offset:0
    v_mfma_f32_16x16x32_bf16 v[108:111], v[96:99], v[88:91], 0
    v_mfma_f32_16x16x32_bf16 v[128:131], v[88:91], v[100:103], 0
    v_mfma_f32_16x16x32_bf16 v[36:39], v[96:99], v[72:75], 0
    v_mfma_f32_16x16x32_bf16 v[112:115], v[72:75], v[100:103], 0
    s_waitcnt lgkmcnt(3)
    s_barrier
    v_mfma_f32_16x16x32_bf16 v[56:59], v[152:155], v[136:139], v[56:59]
    ds_read_b64_tr_b16 v[92:93], v24 offset:49152
    v_mfma_f32_16x16x32_bf16 v[40:43], v[156:159], v[136:139], v[40:43]
    ds_read_b64_tr_b16 v[94:95], v24 offset:52224
    v_mfma_f32_16x16x32_bf16 v[116:119], v[136:139], v[160:163], v[116:119]
    ds_read_b64_tr_b16 v[96:97], v24 offset:50176
    v_mfma_f32_16x16x32_bf16 v[60:63], v[152:155], v[140:143], v[60:63]
    ds_read_b64_tr_b16 v[98:99], v24 offset:53248
    v_mfma_f32_16x16x32_bf16 v[44:47], v[156:159], v[140:143], v[44:47]
    ds_read_b64_tr_b16 v[100:101], v24 offset:51200
    v_mfma_f32_16x16x32_bf16 v[120:123], v[140:143], v[160:163], v[120:123]
    ds_read_b64_tr_b16 v[102:103], v24 offset:54272
    s_waitcnt lgkmcnt(6)
    ds_read_b128 v[76:79], v28 offset:0
    v_mfma_f32_16x16x32_bf16 v[64:67], v[152:155], v[144:147], v[64:67]
    ds_read_b128 v[80:83], v28 offset:16384
    v_mfma_f32_16x16x32_bf16 v[104:107], v[156:159], v[144:147], v[104:107]
    ds_read_b128 v[84:87], v28 offset:32768
    v_mfma_f32_16x16x32_bf16 v[124:127], v[144:147], v[160:163], v[124:127]
    ds_read_b128 v[88:91], v28 offset:49152
    v_mfma_f32_16x16x32_bf16 v[68:71], v[152:155], v[148:151], v[68:71]
    ds_read_b128 v[72:75], v32 offset:0
    v_mfma_f32_16x16x32_bf16 v[108:111], v[156:159], v[148:151], v[108:111]
    v_mfma_f32_16x16x32_bf16 v[128:131], v[148:151], v[160:163], v[128:131]
    v_mfma_f32_16x16x32_bf16 v[36:39], v[156:159], v[132:135], v[36:39]
    v_mfma_f32_16x16x32_bf16 v[112:115], v[132:135], v[160:163], v[112:115]
    s_waitcnt lgkmcnt(3)
    v_mfma_f32_16x16x32_bf16 v[56:59], v[92:95], v[76:79], v[56:59]
    ds_read_b64_tr_b16 v[152:153], v25 offset:49152
    v_mfma_f32_16x16x32_bf16 v[40:43], v[96:99], v[76:79], v[40:43]
    ds_read_b64_tr_b16 v[154:155], v25 offset:52224
    v_mfma_f32_16x16x32_bf16 v[116:119], v[76:79], v[100:103], v[116:119]
    ds_read_b64_tr_b16 v[156:157], v25 offset:50176
    v_mfma_f32_16x16x32_bf16 v[60:63], v[92:95], v[80:83], v[60:63]
    ds_read_b64_tr_b16 v[158:159], v25 offset:53248
    v_mfma_f32_16x16x32_bf16 v[44:47], v[96:99], v[80:83], v[44:47]
    ds_read_b64_tr_b16 v[160:161], v25 offset:51200
    v_mfma_f32_16x16x32_bf16 v[120:123], v[80:83], v[100:103], v[120:123]
    ds_read_b64_tr_b16 v[162:163], v25 offset:54272
    s_waitcnt lgkmcnt(6)
    ds_read_b128 v[136:139], v29 offset:0
    v_mfma_f32_16x16x32_bf16 v[64:67], v[92:95], v[84:87], v[64:67]
    ds_read_b128 v[140:143], v29 offset:16384
    v_mfma_f32_16x16x32_bf16 v[104:107], v[96:99], v[84:87], v[104:107]
    ds_read_b128 v[144:147], v29 offset:32768
    v_mfma_f32_16x16x32_bf16 v[124:127], v[84:87], v[100:103], v[124:127]
    ds_read_b128 v[148:151], v29 offset:49152
    v_mfma_f32_16x16x32_bf16 v[68:71], v[92:95], v[88:91], v[68:71]
    ds_read_b128 v[132:135], v33 offset:0
    v_mfma_f32_16x16x32_bf16 v[108:111], v[96:99], v[88:91], v[108:111]
    v_mfma_f32_16x16x32_bf16 v[128:131], v[88:91], v[100:103], v[128:131]
    v_mfma_f32_16x16x32_bf16 v[36:39], v[96:99], v[72:75], v[36:39]
    v_mfma_f32_16x16x32_bf16 v[112:115], v[72:75], v[100:103], v[112:115]
    s_waitcnt lgkmcnt(3)
    s_barrier
    v_mfma_f32_16x16x32_bf16 v[56:59], v[152:155], v[136:139], v[56:59]
    ds_read_b64_tr_b16 v[92:93], v24 offset:0
    v_mfma_f32_16x16x32_bf16 v[40:43], v[156:159], v[136:139], v[40:43]
    ds_read_b64_tr_b16 v[94:95], v24 offset:3072
    v_mfma_f32_16x16x32_bf16 v[116:119], v[136:139], v[160:163], v[116:119]
    ds_read_b64_tr_b16 v[96:97], v24 offset:1024
    v_mfma_f32_16x16x32_bf16 v[60:63], v[152:155], v[140:143], v[60:63]
    ds_read_b64_tr_b16 v[98:99], v24 offset:4096
    v_mfma_f32_16x16x32_bf16 v[44:47], v[156:159], v[140:143], v[44:47]
    ds_read_b64_tr_b16 v[100:101], v24 offset:2048
    v_mfma_f32_16x16x32_bf16 v[120:123], v[140:143], v[160:163], v[120:123]
    ds_read_b64_tr_b16 v[102:103], v24 offset:5120
    s_waitcnt lgkmcnt(6)
    ds_read_b128 v[76:79], v26 offset:256
    v_mfma_f32_16x16x32_bf16 v[64:67], v[152:155], v[144:147], v[64:67]
    ds_read_b128 v[80:83], v26 offset:16640
    v_mfma_f32_16x16x32_bf16 v[104:107], v[156:159], v[144:147], v[104:107]
    ds_read_b128 v[84:87], v26 offset:33024
    v_mfma_f32_16x16x32_bf16 v[124:127], v[144:147], v[160:163], v[124:127]
    ds_read_b128 v[88:91], v26 offset:49408
    v_mfma_f32_16x16x32_bf16 v[68:71], v[152:155], v[148:151], v[68:71]
    ds_read_b128 v[72:75], v30 offset:256
    v_mfma_f32_16x16x32_bf16 v[108:111], v[156:159], v[148:151], v[108:111]
    v_mfma_f32_16x16x32_bf16 v[128:131], v[148:151], v[160:163], v[128:131]
    v_mfma_f32_16x16x32_bf16 v[36:39], v[156:159], v[132:135], v[36:39]
    v_mfma_f32_16x16x32_bf16 v[112:115], v[132:135], v[160:163], v[112:115]
    s_waitcnt lgkmcnt(3)
    v_mfma_f32_16x16x32_bf16 v[56:59], v[92:95], v[76:79], v[56:59]
    ds_read_b64_tr_b16 v[152:153], v25 offset:0
    v_mfma_f32_16x16x32_bf16 v[40:43], v[96:99], v[76:79], v[40:43]
    ds_read_b64_tr_b16 v[154:155], v25 offset:3072
    v_mfma_f32_16x16x32_bf16 v[116:119], v[76:79], v[100:103], v[116:119]
    ds_read_b64_tr_b16 v[156:157], v25 offset:1024
    v_mfma_f32_16x16x32_bf16 v[60:63], v[92:95], v[80:83], v[60:63]
    ds_read_b64_tr_b16 v[158:159], v25 offset:4096
    v_mfma_f32_16x16x32_bf16 v[44:47], v[96:99], v[80:83], v[44:47]
    ds_read_b64_tr_b16 v[160:161], v25 offset:2048
    v_mfma_f32_16x16x32_bf16 v[120:123], v[80:83], v[100:103], v[120:123]
    ds_read_b64_tr_b16 v[162:163], v25 offset:5120
    s_waitcnt lgkmcnt(6)
    ds_read_b128 v[136:139], v27 offset:256
    v_mfma_f32_16x16x32_bf16 v[64:67], v[92:95], v[84:87], v[64:67]
    ds_read_b128 v[140:143], v27 offset:16640
    v_mfma_f32_16x16x32_bf16 v[104:107], v[96:99], v[84:87], v[104:107]
    ds_read_b128 v[144:147], v27 offset:33024
    v_mfma_f32_16x16x32_bf16 v[124:127], v[84:87], v[100:103], v[124:127]
    ds_read_b128 v[148:151], v27 offset:49408
    v_mfma_f32_16x16x32_bf16 v[68:71], v[92:95], v[88:91], v[68:71]
    ds_read_b128 v[132:135], v31 offset:256
    v_mfma_f32_16x16x32_bf16 v[108:111], v[96:99], v[88:91], v[108:111]
    v_mfma_f32_16x16x32_bf16 v[128:131], v[88:91], v[100:103], v[128:131]
    v_mfma_f32_16x16x32_bf16 v[36:39], v[96:99], v[72:75], v[36:39]
    v_mfma_f32_16x16x32_bf16 v[112:115], v[72:75], v[100:103], v[112:115]
    s_waitcnt lgkmcnt(3)
    s_barrier
    v_mfma_f32_16x16x32_bf16 v[56:59], v[152:155], v[136:139], v[56:59]
    ds_read_b64_tr_b16 v[92:93], v24 offset:24576
    v_mfma_f32_16x16x32_bf16 v[40:43], v[156:159], v[136:139], v[40:43]
    ds_read_b64_tr_b16 v[94:95], v24 offset:27648
    v_mfma_f32_16x16x32_bf16 v[116:119], v[136:139], v[160:163], v[116:119]
    ds_read_b64_tr_b16 v[96:97], v24 offset:25600
    v_mfma_f32_16x16x32_bf16 v[60:63], v[152:155], v[140:143], v[60:63]
    ds_read_b64_tr_b16 v[98:99], v24 offset:28672
    v_mfma_f32_16x16x32_bf16 v[44:47], v[156:159], v[140:143], v[44:47]
    ds_read_b64_tr_b16 v[100:101], v24 offset:26624
    v_mfma_f32_16x16x32_bf16 v[120:123], v[140:143], v[160:163], v[120:123]
    ds_read_b64_tr_b16 v[102:103], v24 offset:29696
    s_waitcnt lgkmcnt(6)
    ds_read_b128 v[76:79], v28 offset:256
    v_mfma_f32_16x16x32_bf16 v[64:67], v[152:155], v[144:147], v[64:67]
    ds_read_b128 v[80:83], v28 offset:16640
    v_mfma_f32_16x16x32_bf16 v[104:107], v[156:159], v[144:147], v[104:107]
    ds_read_b128 v[84:87], v28 offset:33024
    v_mfma_f32_16x16x32_bf16 v[124:127], v[144:147], v[160:163], v[124:127]
    ds_read_b128 v[88:91], v28 offset:49408
    v_mfma_f32_16x16x32_bf16 v[68:71], v[152:155], v[148:151], v[68:71]
    ds_read_b128 v[72:75], v32 offset:256
    v_mfma_f32_16x16x32_bf16 v[108:111], v[156:159], v[148:151], v[108:111]
    v_mfma_f32_16x16x32_bf16 v[128:131], v[148:151], v[160:163], v[128:131]
    v_mfma_f32_16x16x32_bf16 v[36:39], v[156:159], v[132:135], v[36:39]
    v_mfma_f32_16x16x32_bf16 v[112:115], v[132:135], v[160:163], v[112:115]
    s_waitcnt lgkmcnt(3)
    v_mfma_f32_16x16x32_bf16 v[56:59], v[92:95], v[76:79], v[56:59]
    ds_read_b64_tr_b16 v[152:153], v25 offset:24576
    v_mfma_f32_16x16x32_bf16 v[40:43], v[96:99], v[76:79], v[40:43]
    ds_read_b64_tr_b16 v[154:155], v25 offset:27648
    v_mfma_f32_16x16x32_bf16 v[116:119], v[76:79], v[100:103], v[116:119]
    ds_read_b64_tr_b16 v[156:157], v25 offset:25600
    v_mfma_f32_16x16x32_bf16 v[60:63], v[92:95], v[80:83], v[60:63]
    ds_read_b64_tr_b16 v[158:159], v25 offset:28672
    v_mfma_f32_16x16x32_bf16 v[44:47], v[96:99], v[80:83], v[44:47]
    ds_read_b64_tr_b16 v[160:161], v25 offset:26624
    v_mfma_f32_16x16x32_bf16 v[120:123], v[80:83], v[100:103], v[120:123]
    ds_read_b64_tr_b16 v[162:163], v25 offset:29696
    s_waitcnt lgkmcnt(6)
    ds_read_b128 v[136:139], v29 offset:256
    v_mfma_f32_16x16x32_bf16 v[64:67], v[92:95], v[84:87], v[64:67]
    ds_read_b128 v[140:143], v29 offset:16640
    v_mfma_f32_16x16x32_bf16 v[104:107], v[96:99], v[84:87], v[104:107]
    ds_read_b128 v[144:147], v29 offset:33024
    v_mfma_f32_16x16x32_bf16 v[124:127], v[84:87], v[100:103], v[124:127]
    ds_read_b128 v[148:151], v29 offset:49408
    v_mfma_f32_16x16x32_bf16 v[68:71], v[92:95], v[88:91], v[68:71]
    ds_read_b128 v[132:135], v33 offset:256
    v_mfma_f32_16x16x32_bf16 v[108:111], v[96:99], v[88:91], v[108:111]
    v_mfma_f32_16x16x32_bf16 v[128:131], v[88:91], v[100:103], v[128:131]
    v_mfma_f32_16x16x32_bf16 v[36:39], v[96:99], v[72:75], v[36:39]
    v_mfma_f32_16x16x32_bf16 v[112:115], v[72:75], v[100:103], v[112:115]
    s_waitcnt lgkmcnt(3)
    s_barrier
    v_mfma_f32_16x16x32_bf16 v[56:59], v[152:155], v[136:139], v[56:59]
    ds_read_b64_tr_b16 v[92:93], v24 offset:49152
    v_mfma_f32_16x16x32_bf16 v[40:43], v[156:159], v[136:139], v[40:43]
    ds_read_b64_tr_b16 v[94:95], v24 offset:52224
    v_mfma_f32_16x16x32_bf16 v[116:119], v[136:139], v[160:163], v[116:119]
    ds_read_b64_tr_b16 v[96:97], v24 offset:50176
    v_mfma_f32_16x16x32_bf16 v[60:63], v[152:155], v[140:143], v[60:63]
    ds_read_b64_tr_b16 v[98:99], v24 offset:53248
    v_mfma_f32_16x16x32_bf16 v[44:47], v[156:159], v[140:143], v[44:47]
    ds_read_b64_tr_b16 v[100:101], v24 offset:51200
    v_mfma_f32_16x16x32_bf16 v[120:123], v[140:143], v[160:163], v[120:123]
    ds_read_b64_tr_b16 v[102:103], v24 offset:54272
    s_waitcnt lgkmcnt(6)
    ds_read_b128 v[76:79], v26 offset:512
    v_mfma_f32_16x16x32_bf16 v[64:67], v[152:155], v[144:147], v[64:67]
    ds_read_b128 v[80:83], v26 offset:16896
    v_mfma_f32_16x16x32_bf16 v[104:107], v[156:159], v[144:147], v[104:107]
    ds_read_b128 v[84:87], v26 offset:33280
    v_mfma_f32_16x16x32_bf16 v[124:127], v[144:147], v[160:163], v[124:127]
    ds_read_b128 v[88:91], v26 offset:49664
    v_mfma_f32_16x16x32_bf16 v[68:71], v[152:155], v[148:151], v[68:71]
    ds_read_b128 v[72:75], v30 offset:512
    v_mfma_f32_16x16x32_bf16 v[108:111], v[156:159], v[148:151], v[108:111]
    v_mfma_f32_16x16x32_bf16 v[128:131], v[148:151], v[160:163], v[128:131]
    v_mfma_f32_16x16x32_bf16 v[36:39], v[156:159], v[132:135], v[36:39]
    v_mfma_f32_16x16x32_bf16 v[112:115], v[132:135], v[160:163], v[112:115]
    s_waitcnt lgkmcnt(3)
    v_mfma_f32_16x16x32_bf16 v[56:59], v[92:95], v[76:79], v[56:59]
    ds_read_b64_tr_b16 v[152:153], v25 offset:49152
    v_mfma_f32_16x16x32_bf16 v[40:43], v[96:99], v[76:79], v[40:43]
    ds_read_b64_tr_b16 v[154:155], v25 offset:52224
    v_mfma_f32_16x16x32_bf16 v[116:119], v[76:79], v[100:103], v[116:119]
    ds_read_b64_tr_b16 v[156:157], v25 offset:50176
    v_mfma_f32_16x16x32_bf16 v[60:63], v[92:95], v[80:83], v[60:63]
    ds_read_b64_tr_b16 v[158:159], v25 offset:53248
    v_mfma_f32_16x16x32_bf16 v[44:47], v[96:99], v[80:83], v[44:47]
    ds_read_b64_tr_b16 v[160:161], v25 offset:51200
    v_mfma_f32_16x16x32_bf16 v[120:123], v[80:83], v[100:103], v[120:123]
    ds_read_b64_tr_b16 v[162:163], v25 offset:54272
    s_waitcnt lgkmcnt(6)
    ds_read_b128 v[136:139], v27 offset:512
    v_mfma_f32_16x16x32_bf16 v[64:67], v[92:95], v[84:87], v[64:67]
    ds_read_b128 v[140:143], v27 offset:16896
    v_mfma_f32_16x16x32_bf16 v[104:107], v[96:99], v[84:87], v[104:107]
    ds_read_b128 v[144:147], v27 offset:33280
    v_mfma_f32_16x16x32_bf16 v[124:127], v[84:87], v[100:103], v[124:127]
    ds_read_b128 v[148:151], v27 offset:49664
    v_mfma_f32_16x16x32_bf16 v[68:71], v[92:95], v[88:91], v[68:71]
    ds_read_b128 v[132:135], v31 offset:512
    v_mfma_f32_16x16x32_bf16 v[108:111], v[96:99], v[88:91], v[108:111]
    v_mfma_f32_16x16x32_bf16 v[128:131], v[88:91], v[100:103], v[128:131]
    v_mfma_f32_16x16x32_bf16 v[36:39], v[96:99], v[72:75], v[36:39]
    v_mfma_f32_16x16x32_bf16 v[112:115], v[72:75], v[100:103], v[112:115]
    s_waitcnt lgkmcnt(3)
    s_barrier
    v_mfma_f32_16x16x32_bf16 v[56:59], v[152:155], v[136:139], v[56:59]
    ds_read_b64_tr_b16 v[92:93], v24 offset:0
    v_mfma_f32_16x16x32_bf16 v[40:43], v[156:159], v[136:139], v[40:43]
    ds_read_b64_tr_b16 v[94:95], v24 offset:3072
    v_mfma_f32_16x16x32_bf16 v[116:119], v[136:139], v[160:163], v[116:119]
    ds_read_b64_tr_b16 v[96:97], v24 offset:1024
    v_mfma_f32_16x16x32_bf16 v[60:63], v[152:155], v[140:143], v[60:63]
    ds_read_b64_tr_b16 v[98:99], v24 offset:4096
    v_mfma_f32_16x16x32_bf16 v[44:47], v[156:159], v[140:143], v[44:47]
    ds_read_b64_tr_b16 v[100:101], v24 offset:2048
    v_mfma_f32_16x16x32_bf16 v[120:123], v[140:143], v[160:163], v[120:123]
    ds_read_b64_tr_b16 v[102:103], v24 offset:5120
    s_waitcnt lgkmcnt(6)
    ds_read_b128 v[76:79], v28 offset:512
    v_mfma_f32_16x16x32_bf16 v[64:67], v[152:155], v[144:147], v[64:67]
    ds_read_b128 v[80:83], v28 offset:16896
    v_mfma_f32_16x16x32_bf16 v[104:107], v[156:159], v[144:147], v[104:107]
    ds_read_b128 v[84:87], v28 offset:33280
    v_mfma_f32_16x16x32_bf16 v[124:127], v[144:147], v[160:163], v[124:127]
    ds_read_b128 v[88:91], v28 offset:49664
    v_mfma_f32_16x16x32_bf16 v[68:71], v[152:155], v[148:151], v[68:71]
    ds_read_b128 v[72:75], v32 offset:512
    v_mfma_f32_16x16x32_bf16 v[108:111], v[156:159], v[148:151], v[108:111]
    v_mfma_f32_16x16x32_bf16 v[128:131], v[148:151], v[160:163], v[128:131]
    v_mfma_f32_16x16x32_bf16 v[36:39], v[156:159], v[132:135], v[36:39]
    v_mfma_f32_16x16x32_bf16 v[112:115], v[132:135], v[160:163], v[112:115]
    s_waitcnt lgkmcnt(3)
    v_mfma_f32_16x16x32_bf16 v[56:59], v[92:95], v[76:79], v[56:59]
    ds_read_b64_tr_b16 v[152:153], v25 offset:0
    v_mov_b32 v35, 0xf149f2ca
    v_mfma_f32_16x16x32_bf16 v[40:43], v[96:99], v[76:79], v[40:43]
    ds_read_b64_tr_b16 v[154:155], v25 offset:3072
    s_cmp_eq_u32 s72, 0
    v_mfma_f32_16x16x32_bf16 v[116:119], v[76:79], v[100:103], v[116:119]
    ds_read_b64_tr_b16 v[156:157], v25 offset:1024
    s_cselect_b32 s82, 0xf149f2ca, 0
    v_mfma_f32_16x16x32_bf16 v[60:63], v[92:95], v[80:83], v[60:63]
    ds_read_b64_tr_b16 v[158:159], v25 offset:4096
    v_mov_b32 v180, 0
    v_mfma_f32_16x16x32_bf16 v[44:47], v[96:99], v[80:83], v[44:47]
    ds_read_b64_tr_b16 v[160:161], v25 offset:2048
    v_mov_b32 v181, 0
    v_mfma_f32_16x16x32_bf16 v[120:123], v[80:83], v[100:103], v[120:123]
    ds_read_b64_tr_b16 v[162:163], v25 offset:5120
    v_mov_b32 v182, s82
    s_waitcnt lgkmcnt(6)
    ds_read_b128 v[136:139], v29 offset:512
    v_mfma_f32_16x16x32_bf16 v[64:67], v[92:95], v[84:87], v[64:67]
    ds_read_b128 v[140:143], v29 offset:16896
    v_lshl_add_u32 v5, v2, 2, 0
    v_mfma_f32_16x16x32_bf16 v[104:107], v[96:99], v[84:87], v[104:107]
    ds_read_b128 v[144:147], v29 offset:33280
    v_sub_u32 v4, v3, v5
    v_mfma_f32_16x16x32_bf16 v[124:127], v[84:87], v[100:103], v[124:127]
    ds_read_b128 v[148:151], v29 offset:49664
    v_cmp_gt_u32 vcc, 8, v4
    v_mfma_f32_16x16x32_bf16 v[68:71], v[92:95], v[88:91], v[68:71]
    ds_read_b128 v[132:135], v33 offset:512
    v_cndmask_b32 v164, v35, 0, vcc
    v_mfma_f32_16x16x32_bf16 v[108:111], v[96:99], v[88:91], v[108:111]
    v_cmp_gt_i32 vcc, -8, v4
    v_mfma_f32_16x16x32_bf16 v[128:131], v[88:91], v[100:103], v[128:131]
    s_nop 0
    v_cndmask_b32 v168, v35, 0, vcc
    v_mfma_f32_16x16x32_bf16 v[36:39], v[96:99], v[72:75], v[36:39]
    v_mfma_f32_16x16x32_bf16 v[112:115], v[72:75], v[100:103], v[112:115]
    s_waitcnt lgkmcnt(3)
    s_barrier
    v_mfma_f32_16x16x32_bf16 v[56:59], v[152:155], v[136:139], v[56:59]
    ds_read_b64_tr_b16 v[92:93], v24 offset:24576
    v_cndmask_b32 v172, v35, v182, vcc
    v_mfma_f32_16x16x32_bf16 v[40:43], v[156:159], v[136:139], v[40:43]
    ds_read_b64_tr_b16 v[94:95], v24 offset:27648
    v_cmp_gt_i32 vcc, 0, v4
    v_mfma_f32_16x16x32_bf16 v[116:119], v[136:139], v[160:163], v[116:119]
    ds_read_b64_tr_b16 v[96:97], v24 offset:25600
    v_cndmask_b32 v176, v35, v182, vcc
    v_mfma_f32_16x16x32_bf16 v[60:63], v[152:155], v[140:143], v[60:63]
    ds_read_b64_tr_b16 v[98:99], v24 offset:28672
    v_mov_b32 v4, 0xffff
    v_mfma_f32_16x16x32_bf16 v[44:47], v[156:159], v[140:143], v[44:47]
    ds_read_b64_tr_b16 v[100:101], v24 offset:26624
    v_cndmask_b32 v4, v4, 0, vcc
    v_mfma_f32_16x16x32_bf16 v[120:123], v[140:143], v[160:163], v[120:123]
    ds_read_b64_tr_b16 v[102:103], v24 offset:29696
    v_or_b32 v180, v180, v4
    s_waitcnt lgkmcnt(6)
    ds_read_b128 v[76:79], v26 offset:768
    v_mfma_f32_16x16x32_bf16 v[64:67], v[152:155], v[144:147], v[64:67]
    ds_read_b128 v[80:83], v26 offset:17152
    v_cmp_gt_u32 vcc, 8, v5
    v_mfma_f32_16x16x32_bf16 v[104:107], v[156:159], v[144:147], v[104:107]
    ds_read_b128 v[84:87], v26 offset:33536
    v_cndmask_b32 v176, v35, v176, vcc
    v_mfma_f32_16x16x32_bf16 v[124:127], v[144:147], v[160:163], v[124:127]
    ds_read_b128 v[88:91], v26 offset:49920
    v_lshl_add_u32 v5, v2, 2, 1
    v_mfma_f32_16x16x32_bf16 v[68:71], v[152:155], v[148:151], v[68:71]
    ds_read_b128 v[72:75], v30 offset:768
    v_sub_u32 v4, v3, v5
    v_mfma_f32_16x16x32_bf16 v[108:111], v[156:159], v[148:151], v[108:111]
    v_cmp_gt_u32 vcc, 8, v4
    v_mfma_f32_16x16x32_bf16 v[128:131], v[148:151], v[160:163], v[128:131]
    s_nop 0
    v_cndmask_b32 v165, v35, 0, vcc
    v_mfma_f32_16x16x32_bf16 v[36:39], v[156:159], v[132:135], v[36:39]
    v_mfma_f32_16x16x32_bf16 v[112:115], v[132:135], v[160:163], v[112:115]
    s_waitcnt lgkmcnt(3)
    v_mfma_f32_16x16x32_bf16 v[56:59], v[92:95], v[76:79], v[56:59]
    ds_read_b64_tr_b16 v[152:153], v25 offset:24576
    v_cmp_gt_i32 vcc, -8, v4
    v_mfma_f32_16x16x32_bf16 v[40:43], v[96:99], v[76:79], v[40:43]
    ds_read_b64_tr_b16 v[154:155], v25 offset:27648
    v_cndmask_b32 v169, v35, 0, vcc
    v_mfma_f32_16x16x32_bf16 v[116:119], v[76:79], v[100:103], v[116:119]
    ds_read_b64_tr_b16 v[156:157], v25 offset:25600
    v_cndmask_b32 v173, v35, v182, vcc
    v_mfma_f32_16x16x32_bf16 v[60:63], v[92:95], v[80:83], v[60:63]
    ds_read_b64_tr_b16 v[158:159], v25 offset:28672
    v_cmp_gt_i32 vcc, 0, v4
    v_mfma_f32_16x16x32_bf16 v[44:47], v[96:99], v[80:83], v[44:47]
    ds_read_b64_tr_b16 v[160:161], v25 offset:26624
    v_cndmask_b32 v177, v35, v182, vcc
    v_mfma_f32_16x16x32_bf16 v[120:123], v[80:83], v[100:103], v[120:123]
    ds_read_b64_tr_b16 v[162:163], v25 offset:29696
    v_mov_b32 v4, 0xffff0000
    s_waitcnt lgkmcnt(6)
    ds_read_b128 v[136:139], v27 offset:768
    v_mfma_f32_16x16x32_bf16 v[64:67], v[92:95], v[84:87], v[64:67]
    ds_read_b128 v[140:143], v27 offset:17152
    v_cndmask_b32 v4, v4, 0, vcc
    v_mfma_f32_16x16x32_bf16 v[104:107], v[96:99], v[84:87], v[104:107]
    ds_read_b128 v[144:147], v27 offset:33536
    v_or_b32 v180, v180, v4
    v_mfma_f32_16x16x32_bf16 v[124:127], v[84:87], v[100:103], v[124:127]
    ds_read_b128 v[148:151], v27 offset:49920
    v_cmp_gt_u32 vcc, 8, v5
    v_mfma_f32_16x16x32_bf16 v[68:71], v[92:95], v[88:91], v[68:71]
    ds_read_b128 v[132:135], v31 offset:768
    v_cndmask_b32 v177, v35, v177, vcc
    v_mfma_f32_16x16x32_bf16 v[108:111], v[96:99], v[88:91], v[108:111]
    v_lshl_add_u32 v5, v2, 2, 2
    v_mfma_f32_16x16x32_bf16 v[128:131], v[88:91], v[100:103], v[128:131]
    v_sub_u32 v4, v3, v5
    v_mfma_f32_16x16x32_bf16 v[36:39], v[96:99], v[72:75], v[36:39]
    v_mfma_f32_16x16x32_bf16 v[112:115], v[72:75], v[100:103], v[112:115]
    s_waitcnt lgkmcnt(3)
    s_barrier
    v_mfma_f32_16x16x32_bf16 v[56:59], v[152:155], v[136:139], v[56:59]
    ds_read_b64_tr_b16 v[92:93], v24 offset:49152
    v_cmp_gt_u32 vcc, 8, v4
    v_mfma_f32_16x16x32_bf16 v[40:43], v[156:159], v[136:139], v[40:43]
    ds_read_b64_tr_b16 v[94:95], v24 offset:52224
    v_cndmask_b32 v166, v35, 0, vcc
    v_mfma_f32_16x16x32_bf16 v[116:119], v[136:139], v[160:163], v[116:119]
    ds_read_b64_tr_b16 v[96:97], v24 offset:50176
    v_cmp_gt_i32 vcc, -8, v4
    v_mfma_f32_16x16x32_bf16 v[60:63], v[152:155], v[140:143], v[60:63]
    ds_read_b64_tr_b16 v[98:99], v24 offset:53248
    v_cndmask_b32 v170, v35, 0, vcc
    v_mfma_f32_16x16x32_bf16 v[44:47], v[156:159], v[140:143], v[44:47]
    ds_read_b64_tr_b16 v[100:101], v24 offset:51200
    v_cndmask_b32 v174, v35, v182, vcc
    v_mfma_f32_16x16x32_bf16 v[120:123], v[140:143], v[160:163], v[120:123]
    ds_read_b64_tr_b16 v[102:103], v24 offset:54272
    v_cmp_gt_i32 vcc, 0, v4
    s_waitcnt lgkmcnt(6)
    ds_read_b128 v[76:79], v28 offset:768
    v_mfma_f32_16x16x32_bf16 v[64:67], v[152:155], v[144:147], v[64:67]
    ds_read_b128 v[80:83], v28 offset:17152
    v_cndmask_b32 v178, v35, v182, vcc
    v_mfma_f32_16x16x32_bf16 v[104:107], v[156:159], v[144:147], v[104:107]
    ds_read_b128 v[84:87], v28 offset:33536
    v_mov_b32 v4, 0xffff
    v_mfma_f32_16x16x32_bf16 v[124:127], v[144:147], v[160:163], v[124:127]
    ds_read_b128 v[88:91], v28 offset:49920
    v_cndmask_b32 v4, v4, 0, vcc
    v_mfma_f32_16x16x32_bf16 v[68:71], v[152:155], v[148:151], v[68:71]
    ds_read_b128 v[72:75], v32 offset:768
    v_or_b32 v181, v181, v4
    v_mfma_f32_16x16x32_bf16 v[108:111], v[156:159], v[148:151], v[108:111]
    v_cmp_gt_u32 vcc, 8, v5
    v_mfma_f32_16x16x32_bf16 v[128:131], v[148:151], v[160:163], v[128:131]
    s_nop 0
    v_cndmask_b32 v178, v35, v178, vcc
    v_mfma_f32_16x16x32_bf16 v[36:39], v[156:159], v[132:135], v[36:39]
    v_mfma_f32_16x16x32_bf16 v[112:115], v[132:135], v[160:163], v[112:115]
    s_waitcnt lgkmcnt(3)
    v_mfma_f32_16x16x32_bf16 v[56:59], v[92:95], v[76:79], v[56:59]
    ds_read_b64_tr_b16 v[152:153], v25 offset:49152
    v_lshl_add_u32 v5, v2, 2, 3
    v_mfma_f32_16x16x32_bf16 v[40:43], v[96:99], v[76:79], v[40:43]
    ds_read_b64_tr_b16 v[154:155], v25 offset:52224
    v_sub_u32 v4, v3, v5
    v_mfma_f32_16x16x32_bf16 v[116:119], v[76:79], v[100:103], v[116:119]
    ds_read_b64_tr_b16 v[156:157], v25 offset:50176
    v_cmp_gt_u32 vcc, 8, v4
    v_mfma_f32_16x16x32_bf16 v[60:63], v[92:95], v[80:83], v[60:63]
    ds_read_b64_tr_b16 v[158:159], v25 offset:53248
    v_cndmask_b32 v167, v35, 0, vcc
    v_mfma_f32_16x16x32_bf16 v[44:47], v[96:99], v[80:83], v[44:47]
    ds_read_b64_tr_b16 v[160:161], v25 offset:51200
    v_cmp_gt_i32 vcc, -8, v4
    v_mfma_f32_16x16x32_bf16 v[120:123], v[80:83], v[100:103], v[120:123]
    ds_read_b64_tr_b16 v[162:163], v25 offset:54272
    v_cndmask_b32 v171, v35, 0, vcc
    s_waitcnt lgkmcnt(6)
    ds_read_b128 v[136:139], v29 offset:768
    v_mfma_f32_16x16x32_bf16 v[64:67], v[92:95], v[84:87], v[64:67]
    ds_read_b128 v[140:143], v29 offset:17152
    v_cndmask_b32 v175, v35, v182, vcc
    v_mfma_f32_16x16x32_bf16 v[104:107], v[96:99], v[84:87], v[104:107]
    ds_read_b128 v[144:147], v29 offset:33536
    v_cmp_gt_i32 vcc, 0, v4
    v_mfma_f32_16x16x32_bf16 v[124:127], v[84:87], v[100:103], v[124:127]
    ds_read_b128 v[148:151], v29 offset:49920
    v_cndmask_b32 v179, v35, v182, vcc
    v_mfma_f32_16x16x32_bf16 v[68:71], v[92:95], v[88:91], v[68:71]
    ds_read_b128 v[132:135], v33 offset:768
    v_mov_b32 v4, 0xffff0000
    v_mfma_f32_16x16x32_bf16 v[108:111], v[96:99], v[88:91], v[108:111]
    v_cndmask_b32 v4, v4, 0, vcc
    v_mfma_f32_16x16x32_bf16 v[128:131], v[88:91], v[100:103], v[128:131]
    v_or_b32 v181, v181, v4
    v_mfma_f32_16x16x32_bf16 v[36:39], v[96:99], v[72:75], v[36:39]
    v_mfma_f32_16x16x32_bf16 v[112:115], v[72:75], v[100:103], v[112:115]
    s_waitcnt lgkmcnt(0)
    s_barrier
    v_mfma_f32_16x16x32_bf16 v[56:59], v[152:155], v[136:139], v[56:59]
    v_cmp_gt_u32 vcc, 8, v5
    v_mfma_f32_16x16x32_bf16 v[40:43], v[156:159], v[136:139], v[40:43]
    s_nop 0
    v_cndmask_b32 v179, v35, v179, vcc
    v_mfma_f32_16x16x32_bf16 v[116:119], v[136:139], v[160:163], v[116:119]
    v_mfma_f32_16x16x32_bf16 v[60:63], v[152:155], v[140:143], v[60:63]
    v_mfma_f32_16x16x32_bf16 v[44:47], v[156:159], v[140:143], v[44:47]
    v_mfma_f32_16x16x32_bf16 v[120:123], v[140:143], v[160:163], v[120:123]
    v_mfma_f32_16x16x32_bf16 v[64:67], v[152:155], v[144:147], v[64:67]
    v_mfma_f32_16x16x32_bf16 v[104:107], v[156:159], v[144:147], v[104:107]
    v_mfma_f32_16x16x32_bf16 v[124:127], v[144:147], v[160:163], v[124:127]
    v_mfma_f32_16x16x32_bf16 v[68:71], v[152:155], v[148:151], v[68:71]
    v_mfma_f32_16x16x32_bf16 v[108:111], v[156:159], v[148:151], v[108:111]
    v_mfma_f32_16x16x32_bf16 v[128:131], v[148:151], v[160:163], v[128:131]
    v_mfma_f32_16x16x32_bf16 v[36:39], v[156:159], v[132:135], v[36:39]
    v_mfma_f32_16x16x32_bf16 v[112:115], v[132:135], v[160:163], v[112:115]
    v_mov_b32 v32, 0x3f803f80
    v_mov_b32 v33, 0x3f803f80
    v_cvt_pk_bf16_f32 v24, v56, v57
    v_cvt_pk_bf16_f32 v25, v58, v59
    v_cvt_pk_bf16_f32 v26, v60, v61
    v_cvt_pk_bf16_f32 v27, v62, v63
    v_cvt_pk_bf16_f32 v28, v64, v65
    v_cvt_pk_bf16_f32 v29, v66, v67
    v_cvt_pk_bf16_f32 v30, v68, v69
    v_cvt_pk_bf16_f32 v31, v70, v71
    v_cvt_pk_bf16_f32 v74, v40, v41
    v_cvt_pk_bf16_f32 v75, v42, v43
    v_cvt_pk_bf16_f32 v76, v44, v45
    v_cvt_pk_bf16_f32 v77, v46, v47
    v_cvt_pk_bf16_f32 v78, v104, v105
    v_cvt_pk_bf16_f32 v79, v106, v107
    v_cvt_pk_bf16_f32 v80, v108, v109
    v_cvt_pk_bf16_f32 v81, v110, v111
    v_cvt_pk_bf16_f32 v72, v36, v37
    v_cvt_pk_bf16_f32 v73, v38, v39
    v_mfma_f32_16x16x16_bf16 v[56:59], v[74:75], v[24:25], v[164:167]
    v_cvt_pk_bf16_f32 v82, v112, v113
    v_cvt_pk_bf16_f32 v83, v114, v115
    v_mfma_f32_16x16x16_bf16 v[40:43], v[72:73], v[24:25], v[172:175]
    v_cvt_pk_bf16_f32 v88, v112, v113
    v_cvt_pk_bf16_f32 v89, v114, v115
    v_mfma_f32_16x16x16_bf16 v[60:63], v[76:77], v[26:27], v[164:167]
    v_cvt_pk_bf16_f32 v84, v116, v117
    v_cvt_pk_bf16_f32 v85, v118, v119
    v_mfma_f32_16x16x16_bf16 v[44:47], v[72:73], v[26:27], v[176:179]
    v_cvt_pk_bf16_f32 v90, v120, v121
    v_cvt_pk_bf16_f32 v91, v122, v123
    v_mfma_f32_16x16x16_bf16 v[64:67], v[78:79], v[28:29], v[164:167]
    v_cvt_pk_bf16_f32 v86, v124, v125
    v_cvt_pk_bf16_f32 v87, v126, v127
    v_mfma_f32_16x16x16_bf16 v[104:107], v[74:75], v[28:29], v[168:171]
    v_cvt_pk_bf16_f32 v92, v128, v129
    v_cvt_pk_bf16_f32 v93, v130, v131
    v_mfma_f32_16x16x16_bf16 v[68:71], v[80:81], v[30:31], v[164:167]
    v_mfma_f32_16x16x16_bf16 v[108:111], v[76:77], v[30:31], v[168:171]
    v_max_f32 v56, v56, v40
    v_max_f32 v57, v57, v41
    v_max_f32 v58, v58, v42
    v_max_f32 v59, v59, v43
    v_max3_f32 v94, v56, v57, v58
    v_max_f32 v94, v94, v59
    v_max_f32 v60, v60, v44
    v_max_f32 v61, v61, v45
    v_max_f32 v62, v62, v46
    v_max_f32 v63, v63, v47
    v_max3_f32 v95, v60, v61, v62
    v_max_f32 v95, v95, v63
    v_max_f32 v64, v64, v104
    v_max_f32 v65, v65, v105
    v_max_f32 v66, v66, v106
    v_max_f32 v67, v67, v107
    v_max3_f32 v96, v64, v65, v66
    v_max_f32 v96, v96, v67
    v_max_f32 v68, v68, v108
    v_max_f32 v69, v69, v109
    v_max_f32 v70, v70, v110
    v_max_f32 v71, v71, v111
    v_max3_f32 v97, v68, v69, v70
    v_max_f32 v97, v97, v71
    s_mov_b32 s89, 0x3eb8aa3b
    v_permlane32_swap_b32 v94, v96
    v_permlane32_swap_b32 v95, v97
    v_max_f32 v94, v94, v96
    v_max_f32 v95, v95, v97
    s_nop 1
    v_permlane16_swap_b32 v94, v95
    v_max_f32 v94, v94, v95
    v_mul_f32 v94, 0xbeb8aa3b, v94
    v_mov_b32 v95, v94
    s_nop 1
    v_permlane16_swap_b32 v94, v95
    v_mov_b32 v96, v94
    v_mov_b32 v97, v95
    s_nop 0
    v_permlane32_swap_b32 v94, v96
    v_permlane32_swap_b32 v95, v97
    v_fma_f32 v56, v56, s89, v94
    v_fma_f32 v57, v57, s89, v94
    v_fma_f32 v58, v58, s89, v94
L_pg5:
    s_cbranch_execz L_warmed
    v_fma_f32 v59, v59, s89, v94
    v_exp_f32 v56, v56
    v_exp_f32 v57, v57
    v_exp_f32 v58, v58
    v_exp_f32 v59, v59
    v_cvt_pk_bf16_f32 v24, v56, v57
    v_cvt_pk_bf16_f32 v25, v58, v59
    v_and_b32 v42, v24, v180
    v_and_b32 v43, v25, v181
    v_xor_b32 v40, v24, v42
    v_xor_b32 v41, v25, v43
    v_mfma_f32_16x16x16_bf16 v[100:103], v[32:33], v[24:25], 0
    s_nop 0
    v_mfma_f32_16x16x32_bf16 v[112:115], v[82:85], v[40:43], 0
    v_fma_f32 v60, v60, s89, v95
    v_fma_f32 v61, v61, s89, v95
    v_fma_f32 v62, v62, s89, v95
    v_fma_f32 v63, v63, s89, v95
    v_exp_f32 v60, v60
    v_exp_f32 v61, v61
    v_exp_f32 v62, v62
    v_exp_f32 v63, v63
    v_cvt_pk_bf16_f32 v26, v60, v61
    v_cvt_pk_bf16_f32 v27, v62, v63
    v_and_b32 v46, v26, v180
    v_and_b32 v47, v27, v181
    v_xor_b32 v44, v26, v46
    v_xor_b32 v45, v27, v47
    v_mfma_f32_16x16x16_bf16 v[132:135], v[32:33], v[26:27], 0
    s_nop 0
    v_mfma_f32_16x16x32_bf16 v[116:119], v[88:91], v[44:47], 0
    v_fma_f32 v64, v64, s89, v96
    v_fma_f32 v65, v65, s89, v96
    v_fma_f32 v66, v66, s89, v96
    v_fma_f32 v67, v67, s89, v96
    v_exp_f32 v64, v64
    v_exp_f32 v65, v65
    v_exp_f32 v66, v66
    v_exp_f32 v67, v67
    v_cvt_pk_bf16_f32 v28, v64, v65
    v_cvt_pk_bf16_f32 v29, v66, v67
    v_and_b32 v106, v28, v180
    v_and_b32 v107, v29, v181
    v_xor_b32 v104, v28, v106
    v_xor_b32 v105, v29, v107
    v_mfma_f32_16x16x16_bf16 v[136:139], v[32:33], v[28:29], 0
    s_nop 0
    v_mfma_f32_16x16x32_bf16 v[120:123], v[84:87], v[104:107], 0
    v_fma_f32 v68, v68, s89, v97
    v_fma_f32 v69, v69, s89, v97
    v_fma_f32 v70, v70, s89, v97
    v_fma_f32 v71, v71, s89, v97
    v_exp_f32 v68, v68
    v_exp_f32 v69, v69
    v_exp_f32 v70, v70
    v_exp_f32 v71, v71
    v_cvt_pk_bf16_f32 v30, v68, v69
    v_cvt_pk_bf16_f32 v31, v70, v71
    v_and_b32 v110, v30, v180
    v_and_b32 v111, v31, v181
    v_xor_b32 v108, v30, v110
    v_xor_b32 v109, v31, v111
    v_mfma_f32_16x16x16_bf16 v[140:143], v[32:33], v[30:31], 0
    s_nop 0
    v_mfma_f32_16x16x32_bf16 v[124:127], v[90:93], v[108:111], 0
    s_mul_i32 s89, s72, 311296
    s_add_u32 s89, s89, 0x1800000
    s_lshl_b32 s82, s73, 2
    s_add_u32 s82, s82, s77
    s_lshl_b32 s82, s82, 12
    s_add_u32 s82, s82, s89
    v_rcp_f32 v100, v100
    s_nop 0
    v_pk_mul_f32 v[112:113], v[112:113], v[100:101] op_sel_hi:[1,0]
    v_pk_mul_f32 v[114:115], v[114:115], v[100:101] op_sel_hi:[1,0]
    v_cvt_pk_bf16_f32 v56, v112, v113
    v_cvt_pk_bf16_f32 v57, v114, v115
    v_rcp_f32 v132, v132
    s_nop 0
    v_pk_mul_f32 v[116:117], v[116:117], v[132:133] op_sel_hi:[1,0]
    v_pk_mul_f32 v[118:119], v[118:119], v[132:133] op_sel_hi:[1,0]
    v_cvt_pk_bf16_f32 v58, v116, v117
    v_cvt_pk_bf16_f32 v59, v118, v119
    v_rcp_f32 v136, v136
    s_nop 0
    v_pk_mul_f32 v[120:121], v[120:121], v[136:137] op_sel_hi:[1,0]
    v_pk_mul_f32 v[122:123], v[122:123], v[136:137] op_sel_hi:[1,0]
    v_cvt_pk_bf16_f32 v60, v120, v121
    v_cvt_pk_bf16_f32 v61, v122, v123
    v_rcp_f32 v140, v140
    s_nop 0
    v_pk_mul_f32 v[124:125], v[124:125], v[140:141] op_sel_hi:[1,0]
    v_pk_mul_f32 v[126:127], v[126:127], v[140:141] op_sel_hi:[1,0]
    v_cvt_pk_bf16_f32 v62, v124, v125
    v_cvt_pk_bf16_f32 v63, v126, v127
    v_lshlrev_b32 v24, 4, v1
    v_lshrrev_b32 v4, 1, v3
    v_xor_b32 v4, v2, v4
    v_lshlrev_b32 v4, 4, v4
    v_and_b32 v5, 7, v3
    v_lshl_add_u32 v4, v5, 7, v4
    v_lshrrev_b32 v5, 3, v3
    v_lshl_add_u32 v4, v5, 12, v4
    s_lshl_b32 s83, s79, 11
    v_add_u32 v25, s83, v4
    v_xor_b32 v26, 64, v25
    v_add_u32 v27, 0x10000, v25
    v_add_u32 v28, 0x10000, v26
    s_mul_i32 s83, s80, 3072
    s_add_u32 s83, s83, 81920
    v_add_u32 v29, s83, v24
    s_lshl_b32 s83, s79, 10
    v_add_u32 v30, s83, v24
    v_add_u32 v31, 0x10000, v30
    v_add_u32 v32, 0x20000, v30
    s_lshl_b32 s83, s80, 1
    v_lshrrev_b32 v4, 1, v34
    v_xor_b32 v4, s83, v4
    v_lshlrev_b32 v4, 5, v4
    v_lshl_add_u32 v4, v34, 7, v4
    v_and_b32 v5, 3, v3
    v_lshl_add_u32 v4, v5, 3, v4
    v_lshrrev_b32 v5, 1, v2
    v_lshl_add_u32 v33, v5, 10, v4
    v_xor_b32 v35, 32, v33
    v_add_u32 v36, 0x10000, v33
    v_add_u32 v37, 0x10000, v35
    v_add_u32 v38, 0x20000, v33
    v_add_u32 v39, 0x20000, v35
    v_and_b32 v7, 0xffff0000, v6
    v_lshlrev_b32 v6, 16, v6
    v_lshlrev_b32 v24, 4, v1
    v_add_u32 v34, 128, v24
    v_cmp_lt_u32 vcc, 23, v1
    s_nop 1
    v_cndmask_b32 v24, v24, v34, vcc
    v_add_u32 v34, 1024, v24
    v_add_u32 v40, 2048, v24
    v_add_u32 v41, 3072, v24
    buffer_store_dwordx4 v[56:59], v24, s[44:47], s82 offen offset:0 sc1
    buffer_store_dwordx4 v[60:63], v34, s[44:47], s82 offen offset:1024 sc1
    s_lshl_b32 s82, s79, 5
    s_add_u32 s82, s82, s81
    s_lshl_b32 s82, s82, 10
    s_lshl_b32 s83, s73, 7
    s_add_u32 s82, s82, s83
    s_lshl_b32 s83, s80, 6
    s_add_u32 s92, s82, s83
    s_lshl_b32 s82, s80, 1
    v_and_b32 v5, 3, v3
    v_xor_b32 v5, s82, v5
    v_lshlrev_b32 v5, 5, v5
    v_lshl_add_u32 v5, v2, 3, v5
    v_lshl_add_u32 v5, v3, 8, v5
    s_mul_i32 s82, s79, 69632
    s_add_u32 s82, s82, 90112
    v_add_u32 v5, s82, v5
    v_xor_b32 v46, 32, v5
    s_mul_i32 s82, s79, 4608
    s_lshl_b32 s83, s80, 6
    s_add_u32 s83, s83, s82
    s_add_u32 s83, s83, 94208
    v_mul_u32_u24 v44, 144, v3
    v_lshl_add_u32 v44, v2, 3, v44
    v_add_u32 v44, s83, v44
    s_lshl_b32 s83, s80, 3
    v_lshrrev_b32 v4, 3, v1
    v_add_u32 v4, s83, v4
    v_and_b32 v42, 7, v1
    v_lshlrev_b32 v42, 4, v42
    v_mul_u32_u24 v45, 144, v4
    s_add_u32 s82, s82, 94208
    v_add3_u32 v45, v45, v42, s82
    v_lshl_add_u32 v42, v4, 11, v42
    s_lshl_b32 s83, s80, 6
    s_sub_u32 s92, s92, s83
    s_cmp_eq_u32 s75, 1
    s_cselect_b32 s82, 0, 0x80000000
    s_cmp_eq_u32 s80, 0
    s_cselect_b32 s82, 0, s82
    v_or_b32 v43, s82, v24
    s_mul_i32 s82, s80, 3
    s_add_u32 s82, s82, s74
    s_add_u32 s82, s82, 32
    s_lshl_b32 s82, s82, 1
    s_add_u32 s82, s82, s79
    s_lshl_b32 s82, s82, 11
    s_add_u32 s91, s82, s89
    s_add_u32 s90, s91, 8192
    v_mov_b32 v56, v6
    v_mov_b32 v57, v6
    v_mov_b32 v58, v6
    v_mov_b32 v59, v6
    v_mov_b32 v60, v6
    v_mov_b32 v61, v6
    v_mov_b32 v62, v6
    v_mov_b32 v63, v6
    v_mov_b32 v64, v6
    v_mov_b32 v65, v6
    v_mov_b32 v66, v6
    v_mov_b32 v67, v6
    v_mov_b32 v68, v7
    v_mov_b32 v69, v7
    v_mov_b32 v70, v7
    v_mov_b32 v71, v7
    v_mov_b32 v72, v7
    v_mov_b32 v73, v7
    v_mov_b32 v74, v7
    v_mov_b32 v75, v7
    v_mov_b32 v76, v7
    v_mov_b32 v77, v7
    v_mov_b32 v78, v7
    v_mov_b32 v79, v7
    v_mov_b32 v211, s78
    v_mov_b32 v215, s78
    v_mov_b32 v219, s78
    v_mov_b32 v223, s78
    s_lshl_b32 s82, s72, 3
    s_add_u32 s82, s82, s73
    s_lshl_b32 s82, s82, 2
    s_add_u32 s82, s82, s77
    s_lshl_b32 s82, s82, 13
    s_add_u32 s95, s82, 0x1000000
    s_xor_b32 s87, s95, 0x40000
    s_mov_b32 s84, 0xffff0000
    s_barrier
    ds_read_b128 v[120:123], v29 offset:0
    ds_read_b128 v[112:115], v25 offset:8192
    ds_read_b128 v[116:119], v25 offset:9216
    ds_read_b128 v[124:127], v29 offset:1024
    ds_read_b128 v[128:131], v29 offset:2048
    ds_read_b128 v[104:107], v25 offset:0
    ds_read_b128 v[108:111], v25 offset:1024
    s_waitcnt lgkmcnt(2)
    v_mfma_f32_16x16x32_bf16 v[80:83], v[120:123], v[112:115], 0
    ds_read_b128 v[148:151], v29 offset:6144
    v_mfma_f32_16x16x32_bf16 v[84:87], v[124:127], v[112:115], 0
    ds_read_b128 v[140:143], v26 offset:8192
    v_mfma_f32_16x16x32_bf16 v[88:91], v[128:131], v[112:115], 0
    ds_read_b128 v[144:147], v26 offset:9216
    v_mfma_f32_16x16x32_bf16 v[100:103], v[128:131], v[116:119], 0
    ds_read_b128 v[152:155], v29 offset:7168
    v_mfma_f32_16x16x32_bf16 v[96:99], v[124:127], v[116:119], 0
    ds_read_b128 v[156:159], v29 offset:8192
    v_mfma_f32_16x16x32_bf16 v[92:95], v[120:123], v[116:119], 0
    ds_read_b128 v[132:135], v26 offset:0
    s_waitcnt lgkmcnt(6)
    ds_read_b128 v[136:139], v26 offset:1024
    v_mfma_f32_16x16x32_bf16 v[56:59], v[120:123], v[104:107], v[56:59]
    v_mfma_f32_16x16x32_bf16 v[60:63], v[124:127], v[104:107], v[60:63]
    v_mfma_f32_16x16x32_bf16 v[64:67], v[128:131], v[104:107], v[64:67]
    v_mfma_f32_16x16x32_bf16 v[76:79], v[128:131], v[108:111], v[76:79]
    v_mfma_f32_16x16x32_bf16 v[72:75], v[124:127], v[108:111], v[72:75]
    v_mfma_f32_16x16x32_bf16 v[68:71], v[120:123], v[108:111], v[68:71]
    s_waitcnt lgkmcnt(0)
    s_barrier
    v_mfma_f32_16x16x32_bf16 v[80:83], v[148:151], v[140:143], v[80:83]
    ds_read_b128 v[120:123], v29 offset:12288
    v_mfma_f32_16x16x32_bf16 v[84:87], v[152:155], v[140:143], v[84:87]
    ds_read_b128 v[112:115], v25 offset:24576
    v_mfma_f32_16x16x32_bf16 v[88:91], v[156:159], v[140:143], v[88:91]
    ds_read_b128 v[116:119], v25 offset:25600
    v_mfma_f32_16x16x32_bf16 v[100:103], v[156:159], v[144:147], v[100:103]
    ds_read_b128 v[124:127], v29 offset:13312
    v_mfma_f32_16x16x32_bf16 v[96:99], v[152:155], v[144:147], v[96:99]
    ds_read_b128 v[128:131], v29 offset:14336
    v_mfma_f32_16x16x32_bf16 v[92:95], v[148:151], v[144:147], v[92:95]
    ds_read_b128 v[104:107], v25 offset:16384
    ds_read_b128 v[108:111], v25 offset:17408
    v_mfma_f32_16x16x32_bf16 v[56:59], v[148:151], v[132:135], v[56:59]
    v_mfma_f32_16x16x32_bf16 v[60:63], v[152:155], v[132:135], v[60:63]
    v_mfma_f32_16x16x32_bf16 v[64:67], v[156:159], v[132:135], v[64:67]
    v_mfma_f32_16x16x32_bf16 v[76:79], v[156:159], v[136:139], v[76:79]
    v_mfma_f32_16x16x32_bf16 v[72:75], v[152:155], v[136:139], v[72:75]
    v_mfma_f32_16x16x32_bf16 v[68:71], v[148:151], v[136:139], v[68:71]
    s_waitcnt lgkmcnt(2)
    v_mfma_f32_16x16x32_bf16 v[80:83], v[120:123], v[112:115], v[80:83]
    ds_read_b128 v[148:151], v29 offset:18432
    v_mfma_f32_16x16x32_bf16 v[84:87], v[124:127], v[112:115], v[84:87]
    ds_read_b128 v[140:143], v26 offset:24576
    v_mfma_f32_16x16x32_bf16 v[88:91], v[128:131], v[112:115], v[88:91]
    ds_read_b128 v[144:147], v26 offset:25600
    v_mfma_f32_16x16x32_bf16 v[100:103], v[128:131], v[116:119], v[100:103]
    ds_read_b128 v[152:155], v29 offset:19456
    v_mfma_f32_16x16x32_bf16 v[96:99], v[124:127], v[116:119], v[96:99]
    ds_read_b128 v[156:159], v29 offset:20480
    v_mfma_f32_16x16x32_bf16 v[92:95], v[120:123], v[116:119], v[92:95]
    ds_read_b128 v[132:135], v26 offset:16384
    s_waitcnt lgkmcnt(6)
    ds_read_b128 v[136:139], v26 offset:17408
    v_mfma_f32_16x16x32_bf16 v[56:59], v[120:123], v[104:107], v[56:59]
    v_mfma_f32_16x16x32_bf16 v[60:63], v[124:127], v[104:107], v[60:63]
    v_mfma_f32_16x16x32_bf16 v[64:67], v[128:131], v[104:107], v[64:67]
    v_mfma_f32_16x16x32_bf16 v[76:79], v[128:131], v[108:111], v[76:79]
    v_mfma_f32_16x16x32_bf16 v[72:75], v[124:127], v[108:111], v[72:75]
    v_mfma_f32_16x16x32_bf16 v[68:71], v[120:123], v[108:111], v[68:71]
    s_waitcnt lgkmcnt(0)
    s_waitcnt vmcnt(0)
    s_barrier
    v_mfma_f32_16x16x32_bf16 v[80:83], v[148:151], v[140:143], v[80:83]
    ds_read_b128 v[120:123], v29 offset:24576
    v_mfma_f32_16x16x32_bf16 v[84:87], v[152:155], v[140:143], v[84:87]
    ds_read_b128 v[112:115], v25 offset:40960
    v_mfma_f32_16x16x32_bf16 v[88:91], v[156:159], v[140:143], v[88:91]
    ds_read_b128 v[116:119], v25 offset:41984
    v_mfma_f32_16x16x32_bf16 v[100:103], v[156:159], v[144:147], v[100:103]
    ds_read_b128 v[124:127], v29 offset:25600
    v_mfma_f32_16x16x32_bf16 v[96:99], v[152:155], v[144:147], v[96:99]
    ds_read_b128 v[128:131], v29 offset:26624
    v_mfma_f32_16x16x32_bf16 v[92:95], v[148:151], v[144:147], v[92:95]
    ds_read_b128 v[104:107], v25 offset:32768
    ds_read_b128 v[108:111], v25 offset:33792
    v_mfma_f32_16x16x32_bf16 v[56:59], v[148:151], v[132:135], v[56:59]
    v_mfma_f32_16x16x32_bf16 v[60:63], v[152:155], v[132:135], v[60:63]
    v_mfma_f32_16x16x32_bf16 v[64:67], v[156:159], v[132:135], v[64:67]
    v_mfma_f32_16x16x32_bf16 v[76:79], v[156:159], v[136:139], v[76:79]
    v_mfma_f32_16x16x32_bf16 v[72:75], v[152:155], v[136:139], v[72:75]
    v_mfma_f32_16x16x32_bf16 v[68:71], v[148:151], v[136:139], v[68:71]
    s_waitcnt lgkmcnt(2)
    v_mfma_f32_16x16x32_bf16 v[80:83], v[120:123], v[112:115], v[80:83]
    ds_read_b128 v[148:151], v29 offset:30720
    v_mfma_f32_16x16x32_bf16 v[84:87], v[124:127], v[112:115], v[84:87]
    ds_read_b128 v[140:143], v26 offset:40960
    v_mfma_f32_16x16x32_bf16 v[88:91], v[128:131], v[112:115], v[88:91]
    ds_read_b128 v[144:147], v26 offset:41984
    v_mfma_f32_16x16x32_bf16 v[100:103], v[128:131], v[116:119], v[100:103]
    ds_read_b128 v[152:155], v29 offset:31744
    v_mfma_f32_16x16x32_bf16 v[96:99], v[124:127], v[116:119], v[96:99]
    ds_read_b128 v[156:159], v29 offset:32768
    v_mfma_f32_16x16x32_bf16 v[92:95], v[120:123], v[116:119], v[92:95]
    ds_read_b128 v[132:135], v26 offset:32768
    s_waitcnt lgkmcnt(6)
    ds_read_b128 v[136:139], v26 offset:33792
    v_mfma_f32_16x16x32_bf16 v[56:59], v[120:123], v[104:107], v[56:59]
    v_mfma_f32_16x16x32_bf16 v[60:63], v[124:127], v[104:107], v[60:63]
    v_mfma_f32_16x16x32_bf16 v[64:67], v[128:131], v[104:107], v[64:67]
    v_mfma_f32_16x16x32_bf16 v[76:79], v[128:131], v[108:111], v[76:79]
    v_mfma_f32_16x16x32_bf16 v[72:75], v[124:127], v[108:111], v[72:75]
    v_mfma_f32_16x16x32_bf16 v[68:71], v[120:123], v[108:111], v[68:71]
    s_waitcnt lgkmcnt(0)
    s_barrier
    v_mfma_f32_16x16x32_bf16 v[80:83], v[148:151], v[140:143], v[80:83]
    ds_read_b128 v[120:123], v29 offset:36864
    v_mfma_f32_16x16x32_bf16 v[84:87], v[152:155], v[140:143], v[84:87]
    ds_read_b128 v[112:115], v25 offset:57344
    v_mfma_f32_16x16x32_bf16 v[88:91], v[156:159], v[140:143], v[88:91]
    ds_read_b128 v[116:119], v25 offset:58368
    v_mfma_f32_16x16x32_bf16 v[100:103], v[156:159], v[144:147], v[100:103]
    ds_read_b128 v[124:127], v29 offset:37888
    v_mfma_f32_16x16x32_bf16 v[96:99], v[152:155], v[144:147], v[96:99]
    ds_read_b128 v[128:131], v29 offset:38912
    v_mfma_f32_16x16x32_bf16 v[92:95], v[148:151], v[144:147], v[92:95]
    ds_read_b128 v[104:107], v25 offset:49152
    ds_read_b128 v[108:111], v25 offset:50176
    v_mfma_f32_16x16x32_bf16 v[56:59], v[148:151], v[132:135], v[56:59]
    v_mfma_f32_16x16x32_bf16 v[60:63], v[152:155], v[132:135], v[60:63]
    v_mfma_f32_16x16x32_bf16 v[64:67], v[156:159], v[132:135], v[64:67]
    v_mfma_f32_16x16x32_bf16 v[76:79], v[156:159], v[136:139], v[76:79]
    v_mfma_f32_16x16x32_bf16 v[72:75], v[152:155], v[136:139], v[72:75]
    v_mfma_f32_16x16x32_bf16 v[68:71], v[148:151], v[136:139], v[68:71]
    s_waitcnt lgkmcnt(2)
    v_mfma_f32_16x16x32_bf16 v[80:83], v[120:123], v[112:115], v[80:83]
    ds_read_b128 v[148:151], v29 offset:43008
    v_mfma_f32_16x16x32_bf16 v[84:87], v[124:127], v[112:115], v[84:87]
    ds_read_b128 v[140:143], v26 offset:57344
    v_mfma_f32_16x16x32_bf16 v[88:91], v[128:131], v[112:115], v[88:91]
    ds_read_b128 v[144:147], v26 offset:58368
    v_mfma_f32_16x16x32_bf16 v[100:103], v[128:131], v[116:119], v[100:103]
    ds_read_b128 v[152:155], v29 offset:44032
    v_mfma_f32_16x16x32_bf16 v[96:99], v[124:127], v[116:119], v[96:99]
    ds_read_b128 v[156:159], v29 offset:45056
    v_mfma_f32_16x16x32_bf16 v[92:95], v[120:123], v[116:119], v[92:95]
    ds_read_b128 v[132:135], v26 offset:49152
    s_waitcnt lgkmcnt(6)
    ds_read_b128 v[136:139], v26 offset:50176
    v_mfma_f32_16x16x32_bf16 v[56:59], v[120:123], v[104:107], v[56:59]
    v_mfma_f32_16x16x32_bf16 v[60:63], v[124:127], v[104:107], v[60:63]
    v_mfma_f32_16x16x32_bf16 v[64:67], v[128:131], v[104:107], v[64:67]
    v_mfma_f32_16x16x32_bf16 v[76:79], v[128:131], v[108:111], v[76:79]
    v_mfma_f32_16x16x32_bf16 v[72:75], v[124:127], v[108:111], v[72:75]
    v_mfma_f32_16x16x32_bf16 v[68:71], v[120:123], v[108:111], v[68:71]
    s_waitcnt lgkmcnt(0)
    s_barrier
    v_mfma_f32_16x16x32_bf16 v[80:83], v[148:151], v[140:143], v[80:83]
    ds_read_b128 v[120:123], v29 offset:49152
    v_mfma_f32_16x16x32_bf16 v[84:87], v[152:155], v[140:143], v[84:87]
    ds_read_b128 v[112:115], v27 offset:8192
    v_mfma_f32_16x16x32_bf16 v[88:91], v[156:159], v[140:143], v[88:91]
    ds_read_b128 v[116:119], v27 offset:9216
    v_mfma_f32_16x16x32_bf16 v[100:103], v[156:159], v[144:147], v[100:103]
    ds_read_b128 v[124:127], v29 offset:50176
    v_mfma_f32_16x16x32_bf16 v[96:99], v[152:155], v[144:147], v[96:99]
    ds_read_b128 v[128:131], v29 offset:51200
    v_mfma_f32_16x16x32_bf16 v[92:95], v[148:151], v[144:147], v[92:95]
    ds_read_b128 v[104:107], v27 offset:0
    ds_read_b128 v[108:111], v27 offset:1024
    v_mfma_f32_16x16x32_bf16 v[56:59], v[148:151], v[132:135], v[56:59]
    v_mfma_f32_16x16x32_bf16 v[60:63], v[152:155], v[132:135], v[60:63]
    v_mfma_f32_16x16x32_bf16 v[64:67], v[156:159], v[132:135], v[64:67]
    v_mfma_f32_16x16x32_bf16 v[76:79], v[156:159], v[136:139], v[76:79]
    v_mfma_f32_16x16x32_bf16 v[72:75], v[152:155], v[136:139], v[72:75]
    v_mfma_f32_16x16x32_bf16 v[68:71], v[148:151], v[136:139], v[68:71]
    s_waitcnt lgkmcnt(2)
    v_mfma_f32_16x16x32_bf16 v[80:83], v[120:123], v[112:115], v[80:83]
    ds_read_b128 v[148:151], v29 offset:55296
    v_mfma_f32_16x16x32_bf16 v[84:87], v[124:127], v[112:115], v[84:87]
    ds_read_b128 v[140:143], v28 offset:8192
    v_mfma_f32_16x16x32_bf16 v[88:91], v[128:131], v[112:115], v[88:91]
    ds_read_b128 v[144:147], v28 offset:9216
    v_mfma_f32_16x16x32_bf16 v[100:103], v[128:131], v[116:119], v[100:103]
    ds_read_b128 v[152:155], v29 offset:56320
    v_mfma_f32_16x16x32_bf16 v[96:99], v[124:127], v[116:119], v[96:99]
    ds_read_b128 v[156:159], v29 offset:57344
    v_mfma_f32_16x16x32_bf16 v[92:95], v[120:123], v[116:119], v[92:95]
    ds_read_b128 v[132:135], v28 offset:0
    s_waitcnt lgkmcnt(6)
    ds_read_b128 v[136:139], v28 offset:1024
    v_mfma_f32_16x16x32_bf16 v[56:59], v[120:123], v[104:107], v[56:59]
    v_mfma_f32_16x16x32_bf16 v[60:63], v[124:127], v[104:107], v[60:63]
    v_mfma_f32_16x16x32_bf16 v[64:67], v[128:131], v[104:107], v[64:67]
    v_mfma_f32_16x16x32_bf16 v[76:79], v[128:131], v[108:111], v[76:79]
    v_mfma_f32_16x16x32_bf16 v[72:75], v[124:127], v[108:111], v[72:75]
    v_mfma_f32_16x16x32_bf16 v[68:71], v[120:123], v[108:111], v[68:71]
    s_waitcnt lgkmcnt(0)
    s_barrier
    v_mfma_f32_16x16x32_bf16 v[80:83], v[148:151], v[140:143], v[80:83]
    ds_read_b128 v[120:123], v29 offset:0
    v_mfma_f32_16x16x32_bf16 v[84:87], v[152:155], v[140:143], v[84:87]
    ds_read_b128 v[112:115], v25 offset:8192
    v_mfma_f32_16x16x32_bf16 v[88:91], v[156:159], v[140:143], v[88:91]
    ds_read_b128 v[116:119], v25 offset:9216
    v_mfma_f32_16x16x32_bf16 v[100:103], v[156:159], v[144:147], v[100:103]
    ds_read_b128 v[124:127], v29 offset:1024
    v_mfma_f32_16x16x32_bf16 v[96:99], v[152:155], v[144:147], v[96:99]
    ds_read_b128 v[128:131], v29 offset:2048
    v_mfma_f32_16x16x32_bf16 v[92:95], v[148:151], v[144:147], v[92:95]
    ds_read_b128 v[104:107], v25 offset:0
    ds_read_b128 v[108:111], v25 offset:1024
    v_mfma_f32_16x16x32_bf16 v[56:59], v[148:151], v[132:135], v[56:59]
    v_mfma_f32_16x16x32_bf16 v[60:63], v[152:155], v[132:135], v[60:63]
    v_mfma_f32_16x16x32_bf16 v[64:67], v[156:159], v[132:135], v[64:67]
    v_mfma_f32_16x16x32_bf16 v[76:79], v[156:159], v[136:139], v[76:79]
    v_mfma_f32_16x16x32_bf16 v[72:75], v[152:155], v[136:139], v[72:75]
    v_mfma_f32_16x16x32_bf16 v[68:71], v[148:151], v[136:139], v[68:71]
    s_waitcnt lgkmcnt(2)
    v_mfma_f32_16x16x32_bf16 v[80:83], v[120:123], v[112:115], v[80:83]
    ds_read_b128 v[148:151], v29 offset:6144
    v_mfma_f32_16x16x32_bf16 v[84:87], v[124:127], v[112:115], v[84:87]
    ds_read_b128 v[140:143], v26 offset:8192
    v_mfma_f32_16x16x32_bf16 v[88:91], v[128:131], v[112:115], v[88:91]
    ds_read_b128 v[144:147], v26 offset:9216
    v_mfma_f32_16x16x32_bf16 v[100:103], v[128:131], v[116:119], v[100:103]
    ds_read_b128 v[152:155], v29 offset:7168
    v_mfma_f32_16x16x32_bf16 v[96:99], v[124:127], v[116:119], v[96:99]
    ds_read_b128 v[156:159], v29 offset:8192
    v_mfma_f32_16x16x32_bf16 v[92:95], v[120:123], v[116:119], v[92:95]
    ds_read_b128 v[132:135], v26 offset:0
    s_waitcnt lgkmcnt(6)
    ds_read_b128 v[136:139], v26 offset:1024
    v_mfma_f32_16x16x32_bf16 v[56:59], v[120:123], v[104:107], v[56:59]
    v_mfma_f32_16x16x32_bf16 v[60:63], v[124:127], v[104:107], v[60:63]
    v_mfma_f32_16x16x32_bf16 v[64:67], v[128:131], v[104:107], v[64:67]
    v_mfma_f32_16x16x32_bf16 v[76:79], v[128:131], v[108:111], v[76:79]
    v_mfma_f32_16x16x32_bf16 v[72:75], v[124:127], v[108:111], v[72:75]
    v_mfma_f32_16x16x32_bf16 v[68:71], v[120:123], v[108:111], v[68:71]
    s_waitcnt lgkmcnt(0)
    s_barrier
    v_mfma_f32_16x16x32_bf16 v[80:83], v[148:151], v[140:143], v[80:83]
    ds_read_b128 v[120:123], v29 offset:12288
    v_mfma_f32_16x16x32_bf16 v[84:87], v[152:155], v[140:143], v[84:87]
    ds_read_b128 v[112:115], v25 offset:24576
    v_mfma_f32_16x16x32_bf16 v[88:91], v[156:159], v[140:143], v[88:91]
    ds_read_b128 v[116:119], v25 offset:25600
    v_mfma_f32_16x16x32_bf16 v[100:103], v[156:159], v[144:147], v[100:103]
    ds_read_b128 v[124:127], v29 offset:13312
    v_mfma_f32_16x16x32_bf16 v[96:99], v[152:155], v[144:147], v[96:99]
    ds_read_b128 v[128:131], v29 offset:14336
    v_mfma_f32_16x16x32_bf16 v[92:95], v[148:151], v[144:147], v[92:95]
    ds_read_b128 v[104:107], v25 offset:16384
    ds_read_b128 v[108:111], v25 offset:17408
    v_mfma_f32_16x16x32_bf16 v[56:59], v[148:151], v[132:135], v[56:59]
    v_mfma_f32_16x16x32_bf16 v[60:63], v[152:155], v[132:135], v[60:63]
    v_mfma_f32_16x16x32_bf16 v[64:67], v[156:159], v[132:135], v[64:67]
    v_mfma_f32_16x16x32_bf16 v[76:79], v[156:159], v[136:139], v[76:79]
    v_mfma_f32_16x16x32_bf16 v[72:75], v[152:155], v[136:139], v[72:75]
    v_mfma_f32_16x16x32_bf16 v[68:71], v[148:151], v[136:139], v[68:71]
    s_waitcnt lgkmcnt(2)
    v_mfma_f32_16x16x32_bf16 v[80:83], v[120:123], v[112:115], v[80:83]
    ds_read_b128 v[148:151], v29 offset:18432
    v_mfma_f32_16x16x32_bf16 v[84:87], v[124:127], v[112:115], v[84:87]
    ds_read_b128 v[140:143], v26 offset:24576
    v_mfma_f32_16x16x32_bf16 v[88:91], v[128:131], v[112:115], v[88:91]
    ds_read_b128 v[144:147], v26 offset:25600
    v_mfma_f32_16x16x32_bf16 v[100:103], v[128:131], v[116:119], v[100:103]
    ds_read_b128 v[152:155], v29 offset:19456
    v_mfma_f32_16x16x32_bf16 v[96:99], v[124:127], v[116:119], v[96:99]
    ds_read_b128 v[156:159], v29 offset:20480
    v_mfma_f32_16x16x32_bf16 v[92:95], v[120:123], v[116:119], v[92:95]
    ds_read_b128 v[132:135], v26 offset:16384
    s_waitcnt lgkmcnt(6)
    ds_read_b128 v[136:139], v26 offset:17408
    v_mfma_f32_16x16x32_bf16 v[56:59], v[120:123], v[104:107], v[56:59]
    v_mfma_f32_16x16x32_bf16 v[60:63], v[124:127], v[104:107], v[60:63]
    v_mfma_f32_16x16x32_bf16 v[64:67], v[128:131], v[104:107], v[64:67]
    v_mfma_f32_16x16x32_bf16 v[76:79], v[128:131], v[108:111], v[76:79]
    v_mfma_f32_16x16x32_bf16 v[72:75], v[124:127], v[108:111], v[72:75]
    v_mfma_f32_16x16x32_bf16 v[68:71], v[120:123], v[108:111], v[68:71]
    s_waitcnt lgkmcnt(0)
    s_barrier
    v_mfma_f32_16x16x32_bf16 v[80:83], v[148:151], v[140:143], v[80:83]
    ds_read_b128 v[120:123], v29 offset:24576
    v_mfma_f32_16x16x32_bf16 v[84:87], v[152:155], v[140:143], v[84:87]
    ds_read_b128 v[112:115], v25 offset:40960
    v_mfma_f32_16x16x32_bf16 v[88:91], v[156:159], v[140:143], v[88:91]
    ds_read_b128 v[116:119], v25 offset:41984
    v_mfma_f32_16x16x32_bf16 v[100:103], v[156:159], v[144:147], v[100:103]
    ds_read_b128 v[124:127], v29 offset:25600
    v_mfma_f32_16x16x32_bf16 v[96:99], v[152:155], v[144:147], v[96:99]
    ds_read_b128 v[128:131], v29 offset:26624
    v_mfma_f32_16x16x32_bf16 v[92:95], v[148:151], v[144:147], v[92:95]
    ds_read_b128 v[104:107], v25 offset:32768
    ds_read_b128 v[108:111], v25 offset:33792
    v_mfma_f32_16x16x32_bf16 v[56:59], v[148:151], v[132:135], v[56:59]
    v_mfma_f32_16x16x32_bf16 v[60:63], v[152:155], v[132:135], v[60:63]
    v_mfma_f32_16x16x32_bf16 v[64:67], v[156:159], v[132:135], v[64:67]
    v_mfma_f32_16x16x32_bf16 v[76:79], v[156:159], v[136:139], v[76:79]
    v_mfma_f32_16x16x32_bf16 v[72:75], v[152:155], v[136:139], v[72:75]
    v_mfma_f32_16x16x32_bf16 v[68:71], v[148:151], v[136:139], v[68:71]
    s_waitcnt lgkmcnt(2)
    v_mfma_f32_16x16x32_bf16 v[80:83], v[120:123], v[112:115], v[80:83]
    ds_read_b128 v[148:151], v29 offset:30720
    v_mfma_f32_16x16x32_bf16 v[84:87], v[124:127], v[112:115], v[84:87]
    ds_read_b128 v[140:143], v26 offset:40960
    v_mfma_f32_16x16x32_bf16 v[88:91], v[128:131], v[112:115], v[88:91]
    ds_read_b128 v[144:147], v26 offset:41984
    v_mfma_f32_16x16x32_bf16 v[100:103], v[128:131], v[116:119], v[100:103]
    ds_read_b128 v[152:155], v29 offset:31744
    v_mfma_f32_16x16x32_bf16 v[96:99], v[124:127], v[116:119], v[96:99]
    ds_read_b128 v[156:159], v29 offset:32768
    v_mfma_f32_16x16x32_bf16 v[92:95], v[120:123], v[116:119], v[92:95]
    ds_read_b128 v[132:135], v26 offset:32768
    s_waitcnt lgkmcnt(6)
    ds_read_b128 v[136:139], v26 offset:33792
    v_mfma_f32_16x16x32_bf16 v[56:59], v[120:123], v[104:107], v[56:59]
    v_mfma_f32_16x16x32_bf16 v[60:63], v[124:127], v[104:107], v[60:63]
    v_mfma_f32_16x16x32_bf16 v[64:67], v[128:131], v[104:107], v[64:67]
    v_mfma_f32_16x16x32_bf16 v[76:79], v[128:131], v[108:111], v[76:79]
    v_mfma_f32_16x16x32_bf16 v[72:75], v[124:127], v[108:111], v[72:75]
    v_mfma_f32_16x16x32_bf16 v[68:71], v[120:123], v[108:111], v[68:71]
    s_waitcnt lgkmcnt(0)
    s_barrier
    v_mfma_f32_16x16x32_bf16 v[80:83], v[148:151], v[140:143], v[80:83]
    ds_read_b128 v[120:123], v29 offset:36864
    v_mfma_f32_16x16x32_bf16 v[84:87], v[152:155], v[140:143], v[84:87]
    ds_read_b128 v[112:115], v25 offset:57344
    v_mfma_f32_16x16x32_bf16 v[88:91], v[156:159], v[140:143], v[88:91]
    ds_read_b128 v[116:119], v25 offset:58368
    v_mfma_f32_16x16x32_bf16 v[100:103], v[156:159], v[144:147], v[100:103]
    ds_read_b128 v[124:127], v29 offset:37888
    v_mfma_f32_16x16x32_bf16 v[96:99], v[152:155], v[144:147], v[96:99]
    ds_read_b128 v[128:131], v29 offset:38912
    v_mfma_f32_16x16x32_bf16 v[92:95], v[148:151], v[144:147], v[92:95]
    ds_read_b128 v[104:107], v25 offset:49152
    ds_read_b128 v[108:111], v25 offset:50176
    v_mfma_f32_16x16x32_bf16 v[56:59], v[148:151], v[132:135], v[56:59]
    v_mfma_f32_16x16x32_bf16 v[60:63], v[152:155], v[132:135], v[60:63]
    v_mfma_f32_16x16x32_bf16 v[64:67], v[156:159], v[132:135], v[64:67]
    v_mfma_f32_16x16x32_bf16 v[76:79], v[156:159], v[136:139], v[76:79]
    v_mfma_f32_16x16x32_bf16 v[72:75], v[152:155], v[136:139], v[72:75]
    v_mfma_f32_16x16x32_bf16 v[68:71], v[148:151], v[136:139], v[68:71]
    s_waitcnt lgkmcnt(2)
    v_mfma_f32_16x16x32_bf16 v[80:83], v[120:123], v[112:115], v[80:83]
    ds_read_b128 v[148:151], v29 offset:43008
    v_mfma_f32_16x16x32_bf16 v[84:87], v[124:127], v[112:115], v[84:87]
    ds_read_b128 v[140:143], v26 offset:57344
    v_mfma_f32_16x16x32_bf16 v[88:91], v[128:131], v[112:115], v[88:91]
    ds_read_b128 v[144:147], v26 offset:58368
    v_mfma_f32_16x16x32_bf16 v[100:103], v[128:131], v[116:119], v[100:103]
    ds_read_b128 v[152:155], v29 offset:44032
    v_mfma_f32_16x16x32_bf16 v[96:99], v[124:127], v[116:119], v[96:99]
    ds_read_b128 v[156:159], v29 offset:45056
    v_mfma_f32_16x16x32_bf16 v[92:95], v[120:123], v[116:119], v[92:95]
    ds_read_b128 v[132:135], v26 offset:49152
    s_waitcnt lgkmcnt(6)
    ds_read_b128 v[136:139], v26 offset:50176
    v_mfma_f32_16x16x32_bf16 v[56:59], v[120:123], v[104:107], v[56:59]
    v_mfma_f32_16x16x32_bf16 v[60:63], v[124:127], v[104:107], v[60:63]
    v_mfma_f32_16x16x32_bf16 v[64:67], v[128:131], v[104:107], v[64:67]
    v_mfma_f32_16x16x32_bf16 v[76:79], v[128:131], v[108:111], v[76:79]
    v_mfma_f32_16x16x32_bf16 v[72:75], v[124:127], v[108:111], v[72:75]
    v_mfma_f32_16x16x32_bf16 v[68:71], v[120:123], v[108:111], v[68:71]
    s_waitcnt lgkmcnt(0)
    s_barrier
    v_mfma_f32_16x16x32_bf16 v[80:83], v[148:151], v[140:143], v[80:83]
    ds_read_b128 v[120:123], v29 offset:49152
    v_mfma_f32_16x16x32_bf16 v[84:87], v[152:155], v[140:143], v[84:87]
    ds_read_b128 v[112:115], v27 offset:8192
    v_mfma_f32_16x16x32_bf16 v[88:91], v[156:159], v[140:143], v[88:91]
    ds_read_b128 v[116:119], v27 offset:9216
    v_mfma_f32_16x16x32_bf16 v[100:103], v[156:159], v[144:147], v[100:103]
L_pg6:
    s_cbranch_execz L_warmed
    ds_read_b128 v[124:127], v29 offset:50176
    v_mfma_f32_16x16x32_bf16 v[96:99], v[152:155], v[144:147], v[96:99]
    ds_read_b128 v[128:131], v29 offset:51200
    v_mfma_f32_16x16x32_bf16 v[92:95], v[148:151], v[144:147], v[92:95]
    ds_read_b128 v[104:107], v27 offset:0
    ds_read_b128 v[108:111], v27 offset:1024
    v_mfma_f32_16x16x32_bf16 v[56:59], v[148:151], v[132:135], v[56:59]
    v_mfma_f32_16x16x32_bf16 v[60:63], v[152:155], v[132:135], v[60:63]
    v_mfma_f32_16x16x32_bf16 v[64:67], v[156:159], v[132:135], v[64:67]
    v_mfma_f32_16x16x32_bf16 v[76:79], v[156:159], v[136:139], v[76:79]
    v_mfma_f32_16x16x32_bf16 v[72:75], v[152:155], v[136:139], v[72:75]
    v_mfma_f32_16x16x32_bf16 v[68:71], v[148:151], v[136:139], v[68:71]
    s_waitcnt lgkmcnt(2)
    v_mfma_f32_16x16x32_bf16 v[80:83], v[120:123], v[112:115], v[80:83]
    ds_read_b128 v[148:151], v29 offset:55296
    v_mfma_f32_16x16x32_bf16 v[84:87], v[124:127], v[112:115], v[84:87]
    ds_read_b128 v[140:143], v28 offset:8192
    v_mfma_f32_16x16x32_bf16 v[88:91], v[128:131], v[112:115], v[88:91]
    ds_read_b128 v[144:147], v28 offset:9216
    v_mfma_f32_16x16x32_bf16 v[100:103], v[128:131], v[116:119], v[100:103]
    ds_read_b128 v[152:155], v29 offset:56320
    v_mfma_f32_16x16x32_bf16 v[96:99], v[124:127], v[116:119], v[96:99]
    ds_read_b128 v[156:159], v29 offset:57344
    v_mfma_f32_16x16x32_bf16 v[92:95], v[120:123], v[116:119], v[92:95]
    ds_read_b128 v[132:135], v28 offset:0
    s_waitcnt lgkmcnt(6)
    ds_read_b128 v[136:139], v28 offset:1024
    v_mfma_f32_16x16x32_bf16 v[56:59], v[120:123], v[104:107], v[56:59]
    v_mfma_f32_16x16x32_bf16 v[60:63], v[124:127], v[104:107], v[60:63]
    v_mfma_f32_16x16x32_bf16 v[64:67], v[128:131], v[104:107], v[64:67]
    v_mfma_f32_16x16x32_bf16 v[76:79], v[128:131], v[108:111], v[76:79]
    v_mfma_f32_16x16x32_bf16 v[72:75], v[124:127], v[108:111], v[72:75]
    v_mfma_f32_16x16x32_bf16 v[68:71], v[120:123], v[108:111], v[68:71]
    s_waitcnt lgkmcnt(0)
    s_barrier
    v_mfma_f32_16x16x32_bf16 v[80:83], v[148:151], v[140:143], v[80:83]
    ds_read_b128 v[120:123], v29 offset:0
    v_mfma_f32_16x16x32_bf16 v[84:87], v[152:155], v[140:143], v[84:87]
    ds_read_b128 v[112:115], v25 offset:8192
    v_mfma_f32_16x16x32_bf16 v[88:91], v[156:159], v[140:143], v[88:91]
    ds_read_b128 v[116:119], v25 offset:9216
    v_mfma_f32_16x16x32_bf16 v[100:103], v[156:159], v[144:147], v[100:103]
    ds_read_b128 v[124:127], v29 offset:1024
    v_mfma_f32_16x16x32_bf16 v[96:99], v[152:155], v[144:147], v[96:99]
    ds_read_b128 v[128:131], v29 offset:2048
    v_mfma_f32_16x16x32_bf16 v[92:95], v[148:151], v[144:147], v[92:95]
    ds_read_b128 v[104:107], v25 offset:0
    ds_read_b128 v[108:111], v25 offset:1024
    v_mfma_f32_16x16x32_bf16 v[56:59], v[148:151], v[132:135], v[56:59]
    v_mfma_f32_16x16x32_bf16 v[60:63], v[152:155], v[132:135], v[60:63]
    v_mfma_f32_16x16x32_bf16 v[64:67], v[156:159], v[132:135], v[64:67]
    v_mfma_f32_16x16x32_bf16 v[76:79], v[156:159], v[136:139], v[76:79]
    v_mfma_f32_16x16x32_bf16 v[72:75], v[152:155], v[136:139], v[72:75]
    v_mfma_f32_16x16x32_bf16 v[68:71], v[148:151], v[136:139], v[68:71]
    s_waitcnt lgkmcnt(2)
    v_mfma_f32_16x16x32_bf16 v[80:83], v[120:123], v[112:115], v[80:83]
    ds_read_b128 v[148:151], v29 offset:6144
    v_mfma_f32_16x16x32_bf16 v[84:87], v[124:127], v[112:115], v[84:87]
    ds_read_b128 v[140:143], v26 offset:8192
    v_mfma_f32_16x16x32_bf16 v[88:91], v[128:131], v[112:115], v[88:91]
    ds_read_b128 v[144:147], v26 offset:9216
    v_mfma_f32_16x16x32_bf16 v[100:103], v[128:131], v[116:119], v[100:103]
    ds_read_b128 v[152:155], v29 offset:7168
    v_mfma_f32_16x16x32_bf16 v[96:99], v[124:127], v[116:119], v[96:99]
    ds_read_b128 v[156:159], v29 offset:8192
    v_mfma_f32_16x16x32_bf16 v[92:95], v[120:123], v[116:119], v[92:95]
    ds_read_b128 v[132:135], v26 offset:0
    s_waitcnt lgkmcnt(6)
    ds_read_b128 v[136:139], v26 offset:1024
    v_mfma_f32_16x16x32_bf16 v[56:59], v[120:123], v[104:107], v[56:59]
    v_mfma_f32_16x16x32_bf16 v[60:63], v[124:127], v[104:107], v[60:63]
    v_mfma_f32_16x16x32_bf16 v[64:67], v[128:131], v[104:107], v[64:67]
    v_mfma_f32_16x16x32_bf16 v[76:79], v[128:131], v[108:111], v[76:79]
    v_mfma_f32_16x16x32_bf16 v[72:75], v[124:127], v[108:111], v[72:75]
    v_mfma_f32_16x16x32_bf16 v[68:71], v[120:123], v[108:111], v[68:71]
    s_waitcnt lgkmcnt(0)
    s_barrier
    v_mfma_f32_16x16x32_bf16 v[80:83], v[148:151], v[140:143], v[80:83]
    ds_read_b128 v[120:123], v29 offset:12288
    v_mfma_f32_16x16x32_bf16 v[84:87], v[152:155], v[140:143], v[84:87]
    ds_read_b128 v[112:115], v25 offset:24576
    v_mfma_f32_16x16x32_bf16 v[88:91], v[156:159], v[140:143], v[88:91]
    ds_read_b128 v[116:119], v25 offset:25600
    v_mfma_f32_16x16x32_bf16 v[100:103], v[156:159], v[144:147], v[100:103]
    ds_read_b128 v[124:127], v29 offset:13312
    v_mfma_f32_16x16x32_bf16 v[96:99], v[152:155], v[144:147], v[96:99]
    ds_read_b128 v[128:131], v29 offset:14336
    v_mfma_f32_16x16x32_bf16 v[92:95], v[148:151], v[144:147], v[92:95]
    ds_read_b128 v[104:107], v25 offset:16384
    ds_read_b128 v[108:111], v25 offset:17408
    v_mfma_f32_16x16x32_bf16 v[56:59], v[148:151], v[132:135], v[56:59]
    v_mfma_f32_16x16x32_bf16 v[60:63], v[152:155], v[132:135], v[60:63]
    v_mfma_f32_16x16x32_bf16 v[64:67], v[156:159], v[132:135], v[64:67]
    v_mfma_f32_16x16x32_bf16 v[76:79], v[156:159], v[136:139], v[76:79]
    v_mfma_f32_16x16x32_bf16 v[72:75], v[152:155], v[136:139], v[72:75]
    v_mfma_f32_16x16x32_bf16 v[68:71], v[148:151], v[136:139], v[68:71]
    s_waitcnt lgkmcnt(2)
    v_mfma_f32_16x16x32_bf16 v[80:83], v[120:123], v[112:115], v[80:83]
    ds_read_b128 v[148:151], v29 offset:18432
    v_mfma_f32_16x16x32_bf16 v[84:87], v[124:127], v[112:115], v[84:87]
    ds_read_b128 v[140:143], v26 offset:24576
    v_mfma_f32_16x16x32_bf16 v[88:91], v[128:131], v[112:115], v[88:91]
    ds_read_b128 v[144:147], v26 offset:25600
    v_mfma_f32_16x16x32_bf16 v[100:103], v[128:131], v[116:119], v[100:103]
    ds_read_b128 v[152:155], v29 offset:19456
    v_mfma_f32_16x16x32_bf16 v[96:99], v[124:127], v[116:119], v[96:99]
    ds_read_b128 v[156:159], v29 offset:20480
    v_mfma_f32_16x16x32_bf16 v[92:95], v[120:123], v[116:119], v[92:95]
    ds_read_b128 v[132:135], v26 offset:16384
    s_waitcnt lgkmcnt(6)
    ds_read_b128 v[136:139], v26 offset:17408
    v_mfma_f32_16x16x32_bf16 v[56:59], v[120:123], v[104:107], v[56:59]
    v_mfma_f32_16x16x32_bf16 v[60:63], v[124:127], v[104:107], v[60:63]
    v_mfma_f32_16x16x32_bf16 v[64:67], v[128:131], v[104:107], v[64:67]
    v_mfma_f32_16x16x32_bf16 v[76:79], v[128:131], v[108:111], v[76:79]
    v_mfma_f32_16x16x32_bf16 v[72:75], v[124:127], v[108:111], v[72:75]
    v_mfma_f32_16x16x32_bf16 v[68:71], v[120:123], v[108:111], v[68:71]
    s_waitcnt lgkmcnt(0)
    s_barrier
    v_mfma_f32_16x16x32_bf16 v[80:83], v[148:151], v[140:143], v[80:83]
    ds_read_b128 v[120:123], v29 offset:24576
    v_mfma_f32_16x16x32_bf16 v[84:87], v[152:155], v[140:143], v[84:87]
    ds_read_b128 v[112:115], v25 offset:40960
    v_mfma_f32_16x16x32_bf16 v[88:91], v[156:159], v[140:143], v[88:91]
    ds_read_b128 v[116:119], v25 offset:41984
    v_mfma_f32_16x16x32_bf16 v[100:103], v[156:159], v[144:147], v[100:103]
    ds_read_b128 v[124:127], v29 offset:25600
    v_mfma_f32_16x16x32_bf16 v[96:99], v[152:155], v[144:147], v[96:99]
    ds_read_b128 v[128:131], v29 offset:26624
    v_mfma_f32_16x16x32_bf16 v[92:95], v[148:151], v[144:147], v[92:95]
    ds_read_b128 v[104:107], v25 offset:32768
    ds_read_b128 v[108:111], v25 offset:33792
    v_mfma_f32_16x16x32_bf16 v[56:59], v[148:151], v[132:135], v[56:59]
    v_mfma_f32_16x16x32_bf16 v[60:63], v[152:155], v[132:135], v[60:63]
    v_mfma_f32_16x16x32_bf16 v[64:67], v[156:159], v[132:135], v[64:67]
    v_mfma_f32_16x16x32_bf16 v[76:79], v[156:159], v[136:139], v[76:79]
    v_mfma_f32_16x16x32_bf16 v[72:75], v[152:155], v[136:139], v[72:75]
    v_mfma_f32_16x16x32_bf16 v[68:71], v[148:151], v[136:139], v[68:71]
    s_waitcnt lgkmcnt(2)
    v_mfma_f32_16x16x32_bf16 v[80:83], v[120:123], v[112:115], v[80:83]
    ds_read_b128 v[148:151], v29 offset:30720
    v_mfma_f32_16x16x32_bf16 v[84:87], v[124:127], v[112:115], v[84:87]
    ds_read_b128 v[140:143], v26 offset:40960
    v_mfma_f32_16x16x32_bf16 v[88:91], v[128:131], v[112:115], v[88:91]
    ds_read_b128 v[144:147], v26 offset:41984
    v_mfma_f32_16x16x32_bf16 v[100:103], v[128:131], v[116:119], v[100:103]
    ds_read_b128 v[152:155], v29 offset:31744
    v_mfma_f32_16x16x32_bf16 v[96:99], v[124:127], v[116:119], v[96:99]
    ds_read_b128 v[156:159], v29 offset:32768
    v_mfma_f32_16x16x32_bf16 v[92:95], v[120:123], v[116:119], v[92:95]
    ds_read_b128 v[132:135], v26 offset:32768
    s_waitcnt lgkmcnt(6)
    ds_read_b128 v[136:139], v26 offset:33792
    v_mfma_f32_16x16x32_bf16 v[56:59], v[120:123], v[104:107], v[56:59]
    v_mfma_f32_16x16x32_bf16 v[60:63], v[124:127], v[104:107], v[60:63]
    v_mfma_f32_16x16x32_bf16 v[64:67], v[128:131], v[104:107], v[64:67]
    v_mfma_f32_16x16x32_bf16 v[76:79], v[128:131], v[108:111], v[76:79]
    v_mfma_f32_16x16x32_bf16 v[72:75], v[124:127], v[108:111], v[72:75]
    v_mfma_f32_16x16x32_bf16 v[68:71], v[120:123], v[108:111], v[68:71]
    s_waitcnt lgkmcnt(0)
    s_barrier
    v_mfma_f32_16x16x32_bf16 v[80:83], v[148:151], v[140:143], v[80:83]
    ds_read_b128 v[120:123], v29 offset:36864
    v_mfma_f32_16x16x32_bf16 v[84:87], v[152:155], v[140:143], v[84:87]
    ds_read_b128 v[112:115], v25 offset:57344
    v_mfma_f32_16x16x32_bf16 v[88:91], v[156:159], v[140:143], v[88:91]
    ds_read_b128 v[116:119], v25 offset:58368
    v_mfma_f32_16x16x32_bf16 v[100:103], v[156:159], v[144:147], v[100:103]
    ds_read_b128 v[124:127], v29 offset:37888
    v_mfma_f32_16x16x32_bf16 v[96:99], v[152:155], v[144:147], v[96:99]
    ds_read_b128 v[128:131], v29 offset:38912
    v_mfma_f32_16x16x32_bf16 v[92:95], v[148:151], v[144:147], v[92:95]
    ds_read_b128 v[104:107], v25 offset:49152
    ds_read_b128 v[108:111], v25 offset:50176
    v_mfma_f32_16x16x32_bf16 v[56:59], v[148:151], v[132:135], v[56:59]
    v_mfma_f32_16x16x32_bf16 v[60:63], v[152:155], v[132:135], v[60:63]
    v_mfma_f32_16x16x32_bf16 v[64:67], v[156:159], v[132:135], v[64:67]
    v_mfma_f32_16x16x32_bf16 v[76:79], v[156:159], v[136:139], v[76:79]
    v_mfma_f32_16x16x32_bf16 v[72:75], v[152:155], v[136:139], v[72:75]
    v_mfma_f32_16x16x32_bf16 v[68:71], v[148:151], v[136:139], v[68:71]
    s_waitcnt lgkmcnt(2)
    v_mfma_f32_16x16x32_bf16 v[80:83], v[120:123], v[112:115], v[80:83]
    ds_read_b128 v[148:151], v29 offset:43008
    v_mfma_f32_16x16x32_bf16 v[84:87], v[124:127], v[112:115], v[84:87]
    ds_read_b128 v[140:143], v26 offset:57344
    v_mfma_f32_16x16x32_bf16 v[88:91], v[128:131], v[112:115], v[88:91]
    ds_read_b128 v[144:147], v26 offset:58368
    v_mfma_f32_16x16x32_bf16 v[100:103], v[128:131], v[116:119], v[100:103]
    ds_read_b128 v[152:155], v29 offset:44032
    v_mfma_f32_16x16x32_bf16 v[96:99], v[124:127], v[116:119], v[96:99]
    ds_read_b128 v[156:159], v29 offset:45056
    v_mfma_f32_16x16x32_bf16 v[92:95], v[120:123], v[116:119], v[92:95]
    ds_read_b128 v[132:135], v26 offset:49152
    s_waitcnt lgkmcnt(6)
    ds_read_b128 v[136:139], v26 offset:50176
    v_mfma_f32_16x16x32_bf16 v[56:59], v[120:123], v[104:107], v[56:59]
    v_mfma_f32_16x16x32_bf16 v[60:63], v[124:127], v[104:107], v[60:63]
    v_mfma_f32_16x16x32_bf16 v[64:67], v[128:131], v[104:107], v[64:67]
    v_mfma_f32_16x16x32_bf16 v[76:79], v[128:131], v[108:111], v[76:79]
    v_mfma_f32_16x16x32_bf16 v[72:75], v[124:127], v[108:111], v[72:75]
    v_mfma_f32_16x16x32_bf16 v[68:71], v[120:123], v[108:111], v[68:71]
    s_waitcnt lgkmcnt(0)
    s_barrier
    v_mfma_f32_16x16x32_bf16 v[80:83], v[148:151], v[140:143], v[80:83]
    ds_read_b128 v[120:123], v29 offset:49152
    v_mfma_f32_16x16x32_bf16 v[84:87], v[152:155], v[140:143], v[84:87]
    ds_read_b128 v[112:115], v27 offset:8192
    v_mfma_f32_16x16x32_bf16 v[88:91], v[156:159], v[140:143], v[88:91]
    ds_read_b128 v[116:119], v27 offset:9216
    v_mfma_f32_16x16x32_bf16 v[100:103], v[156:159], v[144:147], v[100:103]
    ds_read_b128 v[124:127], v29 offset:50176
    v_mfma_f32_16x16x32_bf16 v[96:99], v[152:155], v[144:147], v[96:99]
    ds_read_b128 v[128:131], v29 offset:51200
    v_mfma_f32_16x16x32_bf16 v[92:95], v[148:151], v[144:147], v[92:95]
    ds_read_b128 v[104:107], v27 offset:0
    ds_read_b128 v[108:111], v27 offset:1024
    v_mfma_f32_16x16x32_bf16 v[56:59], v[148:151], v[132:135], v[56:59]
    v_mfma_f32_16x16x32_bf16 v[60:63], v[152:155], v[132:135], v[60:63]
    v_mfma_f32_16x16x32_bf16 v[64:67], v[156:159], v[132:135], v[64:67]
    v_mfma_f32_16x16x32_bf16 v[76:79], v[156:159], v[136:139], v[76:79]
    v_mfma_f32_16x16x32_bf16 v[72:75], v[152:155], v[136:139], v[72:75]
    v_mfma_f32_16x16x32_bf16 v[68:71], v[148:151], v[136:139], v[68:71]
    s_waitcnt lgkmcnt(2)
    v_mfma_f32_16x16x32_bf16 v[80:83], v[120:123], v[112:115], v[80:83]
    ds_read_b128 v[148:151], v29 offset:55296
    v_mfma_f32_16x16x32_bf16 v[84:87], v[124:127], v[112:115], v[84:87]
    ds_read_b128 v[140:143], v28 offset:8192
    v_mfma_f32_16x16x32_bf16 v[88:91], v[128:131], v[112:115], v[88:91]
    ds_read_b128 v[144:147], v28 offset:9216
    v_mfma_f32_16x16x32_bf16 v[100:103], v[128:131], v[116:119], v[100:103]
    ds_read_b128 v[152:155], v29 offset:56320
    v_mfma_f32_16x16x32_bf16 v[96:99], v[124:127], v[116:119], v[96:99]
    ds_read_b128 v[156:159], v29 offset:57344
    v_mfma_f32_16x16x32_bf16 v[92:95], v[120:123], v[116:119], v[92:95]
    ds_read_b128 v[132:135], v28 offset:0
    s_waitcnt lgkmcnt(6)
    ds_read_b128 v[136:139], v28 offset:1024
    v_mfma_f32_16x16x32_bf16 v[56:59], v[120:123], v[104:107], v[56:59]
    v_mfma_f32_16x16x32_bf16 v[60:63], v[124:127], v[104:107], v[60:63]
    v_mfma_f32_16x16x32_bf16 v[64:67], v[128:131], v[104:107], v[64:67]
    v_mfma_f32_16x16x32_bf16 v[76:79], v[128:131], v[108:111], v[76:79]
    v_mfma_f32_16x16x32_bf16 v[72:75], v[124:127], v[108:111], v[72:75]
    v_mfma_f32_16x16x32_bf16 v[68:71], v[120:123], v[108:111], v[68:71]
    s_waitcnt lgkmcnt(0)
    s_barrier
    v_mfma_f32_16x16x32_bf16 v[80:83], v[148:151], v[140:143], v[80:83]
    ds_read_b128 v[120:123], v29 offset:0
    v_mfma_f32_16x16x32_bf16 v[84:87], v[152:155], v[140:143], v[84:87]
    ds_read_b128 v[112:115], v25 offset:8192
    v_mfma_f32_16x16x32_bf16 v[88:91], v[156:159], v[140:143], v[88:91]
    ds_read_b128 v[116:119], v25 offset:9216
    v_mfma_f32_16x16x32_bf16 v[100:103], v[156:159], v[144:147], v[100:103]
    ds_read_b128 v[124:127], v29 offset:1024
    v_mfma_f32_16x16x32_bf16 v[96:99], v[152:155], v[144:147], v[96:99]
    ds_read_b128 v[128:131], v29 offset:2048
    v_mfma_f32_16x16x32_bf16 v[92:95], v[148:151], v[144:147], v[92:95]
    ds_read_b128 v[104:107], v25 offset:0
    ds_read_b128 v[108:111], v25 offset:1024
    v_mfma_f32_16x16x32_bf16 v[56:59], v[148:151], v[132:135], v[56:59]
    v_mfma_f32_16x16x32_bf16 v[60:63], v[152:155], v[132:135], v[60:63]
    v_mfma_f32_16x16x32_bf16 v[64:67], v[156:159], v[132:135], v[64:67]
    v_mfma_f32_16x16x32_bf16 v[76:79], v[156:159], v[136:139], v[76:79]
    v_mfma_f32_16x16x32_bf16 v[72:75], v[152:155], v[136:139], v[72:75]
    v_mfma_f32_16x16x32_bf16 v[68:71], v[148:151], v[136:139], v[68:71]
    s_waitcnt lgkmcnt(2)
    v_mfma_f32_16x16x32_bf16 v[80:83], v[120:123], v[112:115], v[80:83]
    ds_read_b128 v[148:151], v29 offset:6144
    v_mfma_f32_16x16x32_bf16 v[84:87], v[124:127], v[112:115], v[84:87]
    ds_read_b128 v[140:143], v26 offset:8192
    v_mfma_f32_16x16x32_bf16 v[88:91], v[128:131], v[112:115], v[88:91]
    ds_read_b128 v[144:147], v26 offset:9216
    v_mfma_f32_16x16x32_bf16 v[100:103], v[128:131], v[116:119], v[100:103]
    ds_read_b128 v[152:155], v29 offset:7168
    v_mfma_f32_16x16x32_bf16 v[96:99], v[124:127], v[116:119], v[96:99]
    ds_read_b128 v[156:159], v29 offset:8192
    v_mfma_f32_16x16x32_bf16 v[92:95], v[120:123], v[116:119], v[92:95]
    ds_read_b128 v[132:135], v26 offset:0
    s_waitcnt lgkmcnt(6)
    ds_read_b128 v[136:139], v26 offset:1024
    v_mfma_f32_16x16x32_bf16 v[56:59], v[120:123], v[104:107], v[56:59]
    v_mfma_f32_16x16x32_bf16 v[60:63], v[124:127], v[104:107], v[60:63]
    v_mfma_f32_16x16x32_bf16 v[64:67], v[128:131], v[104:107], v[64:67]
    v_mfma_f32_16x16x32_bf16 v[76:79], v[128:131], v[108:111], v[76:79]
    v_mfma_f32_16x16x32_bf16 v[72:75], v[124:127], v[108:111], v[72:75]
    v_mfma_f32_16x16x32_bf16 v[68:71], v[120:123], v[108:111], v[68:71]
    s_waitcnt lgkmcnt(0)
    s_barrier
    v_mfma_f32_16x16x32_bf16 v[80:83], v[148:151], v[140:143], v[80:83]
    v_mfma_f32_16x16x32_bf16 v[84:87], v[152:155], v[140:143], v[84:87]
    v_mfma_f32_16x16x32_bf16 v[88:91], v[156:159], v[140:143], v[88:91]
    v_mfma_f32_16x16x32_bf16 v[100:103], v[156:159], v[144:147], v[100:103]
    v_mfma_f32_16x16x32_bf16 v[96:99], v[152:155], v[144:147], v[96:99]
    v_mfma_f32_16x16x32_bf16 v[92:95], v[148:151], v[144:147], v[92:95]
    v_mfma_f32_16x16x32_bf16 v[56:59], v[148:151], v[132:135], v[56:59]
    v_mfma_f32_16x16x32_bf16 v[60:63], v[152:155], v[132:135], v[60:63]
    v_mfma_f32_16x16x32_bf16 v[64:67], v[156:159], v[132:135], v[64:67]
    v_mfma_f32_16x16x32_bf16 v[76:79], v[156:159], v[136:139], v[76:79]
    v_mfma_f32_16x16x32_bf16 v[72:75], v[152:155], v[136:139], v[72:75]
    v_mfma_f32_16x16x32_bf16 v[68:71], v[148:151], v[136:139], v[68:71]
    s_setprio 3
    v_cvt_pk_bf16_f32 v208, v80, v81
    v_cvt_pk_bf16_f32 v209, v82, v83
    v_cvt_pk_bf16_f32 v210, v92, v93
    buffer_store_dwordx4 v[208:211], v24, s[44:47], s87 offen offset:0 sc1
    v_cvt_pk_bf16_f32 v212, v94, v95
    v_cvt_pk_bf16_f32 v213, v84, v85
    v_cvt_pk_bf16_f32 v214, v86, v87
    buffer_store_dwordx4 v[212:215], v34, s[44:47], s87 offen offset:1024 sc1
    v_cvt_pk_bf16_f32 v216, v96, v97
    v_cvt_pk_bf16_f32 v217, v98, v99
    v_cvt_pk_bf16_f32 v218, v88, v89
    buffer_store_dwordx4 v[216:219], v40, s[44:47], s87 offen offset:2048 sc1
    v_cvt_pk_bf16_f32 v220, v90, v91
    v_cvt_pk_bf16_f32 v221, v100, v101
    v_cvt_pk_bf16_f32 v222, v102, v103
    buffer_store_dwordx4 v[220:223], v41, s[44:47], s87 offen offset:3072 sc1
L_xsent:
    s_setprio 1
    v_mov_b32 v240, 0xc0135761
    v_mov_b32 v241, 0xbdd2d3e8
    v_pk_mul_f32 v[242:243], v[8:9], v[8:9]
    v_pk_mul_f32 v[244:245], v[10:11], v[10:11]
    v_pk_mul_f32 v[246:247], v[12:13], v[12:13]
    v_pk_mul_f32 v[248:249], v[14:15], v[14:15]
    v_pk_fma_f32 v[242:243], v[242:243], v[240:241], v[240:241] op_sel:[0,1,0] op_sel_hi:[1,1,0]
    v_pk_fma_f32 v[244:245], v[244:245], v[240:241], v[240:241] op_sel:[0,1,0] op_sel_hi:[1,1,0]
    v_pk_fma_f32 v[246:247], v[246:247], v[240:241], v[240:241] op_sel:[0,1,0] op_sel_hi:[1,1,0]
    v_pk_fma_f32 v[248:249], v[248:249], v[240:241], v[240:241] op_sel:[0,1,0] op_sel_hi:[1,1,0]
    v_pk_mul_f32 v[242:243], v[242:243], v[8:9]
    v_pk_mul_f32 v[244:245], v[244:245], v[10:11]
    v_pk_mul_f32 v[246:247], v[246:247], v[12:13]
    v_pk_mul_f32 v[248:249], v[248:249], v[14:15]
    v_exp_f32 v242, v242
    v_exp_f32 v243, v243
    v_exp_f32 v244, v244
    v_exp_f32 v245, v245
    v_exp_f32 v246, v246
    v_exp_f32 v247, v247
    v_exp_f32 v248, v248
    v_exp_f32 v249, v249
    v_pk_add_f32 v[242:243], v[242:243], 1.0 op_sel_hi:[1,0]
    v_pk_add_f32 v[244:245], v[244:245], 1.0 op_sel_hi:[1,0]
    v_pk_add_f32 v[246:247], v[246:247], 1.0 op_sel_hi:[1,0]
    v_pk_add_f32 v[248:249], v[248:249], 1.0 op_sel_hi:[1,0]
    v_rcp_f32 v242, v242
    v_rcp_f32 v243, v243
    v_rcp_f32 v244, v244
    v_rcp_f32 v245, v245
    v_rcp_f32 v246, v246
    v_rcp_f32 v247, v247
    v_rcp_f32 v248, v248
    v_rcp_f32 v249, v249
    v_pk_mul_f32 v[8:9], v[242:243], v[8:9]
    v_pk_mul_f32 v[10:11], v[244:245], v[10:11]
    v_pk_mul_f32 v[12:13], v[246:247], v[12:13]
    v_pk_mul_f32 v[14:15], v[248:249], v[14:15]
    v_pk_mul_f32 v[242:243], v[16:17], v[16:17]
    v_pk_mul_f32 v[244:245], v[18:19], v[18:19]
    v_pk_mul_f32 v[246:247], v[20:21], v[20:21]
    v_pk_mul_f32 v[248:249], v[22:23], v[22:23]
    v_pk_fma_f32 v[242:243], v[242:243], v[240:241], v[240:241] op_sel:[0,1,0] op_sel_hi:[1,1,0]
    v_pk_fma_f32 v[244:245], v[244:245], v[240:241], v[240:241] op_sel:[0,1,0] op_sel_hi:[1,1,0]
    v_pk_fma_f32 v[246:247], v[246:247], v[240:241], v[240:241] op_sel:[0,1,0] op_sel_hi:[1,1,0]
    v_pk_fma_f32 v[248:249], v[248:249], v[240:241], v[240:241] op_sel:[0,1,0] op_sel_hi:[1,1,0]
    v_pk_mul_f32 v[242:243], v[242:243], v[16:17]
    v_pk_mul_f32 v[244:245], v[244:245], v[18:19]
    v_pk_mul_f32 v[246:247], v[246:247], v[20:21]
    v_pk_mul_f32 v[248:249], v[248:249], v[22:23]
    v_exp_f32 v242, v242
    v_exp_f32 v243, v243
    v_exp_f32 v244, v244
    v_exp_f32 v245, v245
    v_exp_f32 v246, v246
    v_exp_f32 v247, v247
    v_exp_f32 v248, v248
    v_exp_f32 v249, v249
    v_pk_add_f32 v[242:243], v[242:243], 1.0 op_sel_hi:[1,0]
    v_pk_add_f32 v[244:245], v[244:245], 1.0 op_sel_hi:[1,0]
    v_pk_add_f32 v[246:247], v[246:247], 1.0 op_sel_hi:[1,0]
    v_pk_add_f32 v[248:249], v[248:249], 1.0 op_sel_hi:[1,0]
    v_rcp_f32 v242, v242
    v_rcp_f32 v243, v243
    v_rcp_f32 v244, v244
    v_rcp_f32 v245, v245
    v_rcp_f32 v246, v246
    v_rcp_f32 v247, v247
    v_rcp_f32 v248, v248
    v_rcp_f32 v249, v249
    v_pk_mul_f32 v[16:17], v[242:243], v[16:17]
    v_pk_mul_f32 v[18:19], v[244:245], v[18:19]
    v_pk_mul_f32 v[20:21], v[246:247], v[20:21]
    v_pk_mul_f32 v[22:23], v[248:249], v[22:23]
    v_pk_mul_f32 v[242:243], v[48:49], v[48:49]
    v_pk_mul_f32 v[244:245], v[50:51], v[50:51]
    v_pk_mul_f32 v[246:247], v[52:53], v[52:53]
    v_pk_mul_f32 v[248:249], v[54:55], v[54:55]
    v_pk_fma_f32 v[242:243], v[242:243], v[240:241], v[240:241] op_sel:[0,1,0] op_sel_hi:[1,1,0]
    v_pk_fma_f32 v[244:245], v[244:245], v[240:241], v[240:241] op_sel:[0,1,0] op_sel_hi:[1,1,0]
    v_pk_fma_f32 v[246:247], v[246:247], v[240:241], v[240:241] op_sel:[0,1,0] op_sel_hi:[1,1,0]
    v_pk_fma_f32 v[248:249], v[248:249], v[240:241], v[240:241] op_sel:[0,1,0] op_sel_hi:[1,1,0]
    v_pk_mul_f32 v[242:243], v[242:243], v[48:49]
    v_pk_mul_f32 v[244:245], v[244:245], v[50:51]
    v_pk_mul_f32 v[246:247], v[246:247], v[52:53]
    v_pk_mul_f32 v[248:249], v[248:249], v[54:55]
    v_exp_f32 v242, v242
    v_exp_f32 v243, v243
    v_exp_f32 v244, v244
    v_exp_f32 v245, v245
    v_exp_f32 v246, v246
    v_exp_f32 v247, v247
    v_exp_f32 v248, v248
    v_exp_f32 v249, v249
    v_pk_add_f32 v[242:243], v[242:243], 1.0 op_sel_hi:[1,0]
    v_pk_add_f32 v[244:245], v[244:245], 1.0 op_sel_hi:[1,0]
    v_pk_add_f32 v[246:247], v[246:247], 1.0 op_sel_hi:[1,0]
    v_pk_add_f32 v[248:249], v[248:249], 1.0 op_sel_hi:[1,0]
    v_rcp_f32 v242, v242
    v_rcp_f32 v243, v243
    v_rcp_f32 v244, v244
    v_rcp_f32 v245, v245
    v_rcp_f32 v246, v246
    v_rcp_f32 v247, v247
    v_rcp_f32 v248, v248
    v_rcp_f32 v249, v249
    v_pk_mul_f32 v[48:49], v[242:243], v[48:49]
    v_pk_mul_f32 v[50:51], v[244:245], v[50:51]
    v_pk_mul_f32 v[52:53], v[246:247], v[52:53]
    v_pk_mul_f32 v[54:55], v[248:249], v[54:55]
    s_waitcnt vmcnt(0)
    s_add_u32 s82, s95, 7292
    s_mov_b32 s88, 32768
L_xh:
    s_buffer_load_dword s48, s[44:47], s82 glc
    s_waitcnt lgkmcnt(0)
    s_cmp_eq_u32 s48, s78
    s_cbranch_scc1 L_xh_ok
    s_sub_u32 s88, s88, 1
    s_cbranch_scc0 L_xh
L_xh_ok:
    buffer_load_dwordx4 v[104:107], v24, s[44:47], s95 offen offset:0 sc1
    buffer_load_dwordx4 v[108:111], v34, s[44:47], s95 offen offset:1024 sc1
    buffer_load_dwordx4 v[112:115], v40, s[44:47], s95 offen offset:2048 sc1
    buffer_load_dwordx4 v[116:119], v41, s[44:47], s95 offen offset:3072 sc1
    s_setprio 3
    s_waitcnt vmcnt(0)
    v_xor_b32 v6, s78, v107
    v_bitop3_b32 v6, v6, v111, s78 bitop3:0xf6
    v_bitop3_b32 v6, v6, v115, s78 bitop3:0xf6
    v_bitop3_b32 v6, v6, v119, s78 bitop3:0xf6
    v_cmp_ne_u32 vcc, 0, v6
    s_cbranch_vccz L_xok
    s_mov_b32 s88, 32768
L_xchk:
    buffer_load_dwordx4 v[104:107], v24, s[44:47], s95 offen offset:0 sc1
    buffer_load_dwordx4 v[108:111], v34, s[44:47], s95 offen offset:1024 sc1
    buffer_load_dwordx4 v[112:115], v40, s[44:47], s95 offen offset:2048 sc1
    buffer_load_dwordx4 v[116:119], v41, s[44:47], s95 offen offset:3072 sc1
    s_waitcnt vmcnt(0)
    v_xor_b32 v6, s78, v107
    v_bitop3_b32 v6, v6, v111, s78 bitop3:0xf6
    v_bitop3_b32 v6, v6, v115, s78 bitop3:0xf6
    v_bitop3_b32 v6, v6, v119, s78 bitop3:0xf6
    v_cmp_ne_u32 vcc, 0, v6
    s_cbranch_vccz L_xok
    s_sub_u32 s88, s88, 1
    s_cbranch_scc0 L_xchk
L_xok:
    v_lshlrev_b32 v80, 16, v104
    v_and_b32 v81, s84, v104
    v_lshlrev_b32 v82, 16, v105
    v_and_b32 v83, s84, v105
    v_lshlrev_b32 v92, 16, v106
    v_and_b32 v93, s84, v106
    v_lshlrev_b32 v94, 16, v108
    v_and_b32 v95, s84, v108
    v_pk_add_f32 v[56:57], v[56:57], v[80:81]
    v_pk_add_f32 v[58:59], v[58:59], v[82:83]
    v_pk_add_f32 v[68:69], v[68:69], v[92:93]
    v_pk_add_f32 v[70:71], v[70:71], v[94:95]
    v_pk_mul_f32 v[56:57], v[56:57], v[8:9]
    v_pk_mul_f32 v[58:59], v[58:59], v[10:11]
    v_pk_mul_f32 v[68:69], v[68:69], v[20:21]
    v_pk_mul_f32 v[70:71], v[70:71], v[22:23]
    v_cvt_pk_bf16_f32 v120, v56, v57
    v_cvt_pk_bf16_f32 v121, v58, v59
    v_cvt_pk_bf16_f32 v122, v68, v69
    v_cvt_pk_bf16_f32 v123, v70, v71
    buffer_store_dwordx4 v[120:123], v24, s[44:47], s91 offen offset:0 sc1
    v_lshlrev_b32 v84, 16, v109
    v_and_b32 v85, s84, v109
    v_lshlrev_b32 v86, 16, v110
    v_and_b32 v87, s84, v110
    v_lshlrev_b32 v96, 16, v112
    v_and_b32 v97, s84, v112
    v_lshlrev_b32 v98, 16, v113
    v_and_b32 v99, s84, v113
    v_pk_add_f32 v[60:61], v[60:61], v[84:85]
    v_pk_add_f32 v[62:63], v[62:63], v[86:87]
    v_pk_add_f32 v[72:73], v[72:73], v[96:97]
    v_pk_add_f32 v[74:75], v[74:75], v[98:99]
    v_pk_mul_f32 v[60:61], v[60:61], v[12:13]
    v_pk_mul_f32 v[62:63], v[62:63], v[14:15]
    v_pk_mul_f32 v[72:73], v[72:73], v[48:49]
    v_pk_mul_f32 v[74:75], v[74:75], v[50:51]
    v_cvt_pk_bf16_f32 v124, v60, v61
    v_cvt_pk_bf16_f32 v125, v62, v63
    v_cvt_pk_bf16_f32 v126, v72, v73
    v_cvt_pk_bf16_f32 v127, v74, v75
    buffer_store_dwordx4 v[124:127], v40, s[44:47], s91 offen offset:2048 sc1
    v_lshlrev_b32 v88, 16, v114
    v_and_b32 v89, s84, v114
    v_lshlrev_b32 v90, 16, v116
    v_and_b32 v91, s84, v116
    v_lshlrev_b32 v100, 16, v117
    v_and_b32 v101, s84, v117
    v_lshlrev_b32 v102, 16, v118
    v_and_b32 v103, s84, v118
    v_pk_add_f32 v[64:65], v[64:65], v[88:89]
    v_pk_add_f32 v[66:67], v[66:67], v[90:91]
    v_pk_add_f32 v[76:77], v[76:77], v[100:101]
    v_pk_add_f32 v[78:79], v[78:79], v[102:103]
    v_pk_mul_f32 v[64:65], v[64:65], v[16:17]
    v_pk_mul_f32 v[66:67], v[66:67], v[18:19]
    v_pk_mul_f32 v[76:77], v[76:77], v[52:53]
    v_pk_mul_f32 v[78:79], v[78:79], v[54:55]
    v_cvt_pk_bf16_f32 v128, v64, v65
    v_cvt_pk_bf16_f32 v129, v66, v67
    v_cvt_pk_bf16_f32 v130, v76, v77
    v_cvt_pk_bf16_f32 v131, v78, v79
    buffer_store_dwordx4 v[128:131], v43, s[44:47], s90 offen sc1
    s_setprio 1
    s_barrier
    ds_read_b128 v[160:163], v30 offset:16384
    ds_read_b128 v[164:167], v30 offset:18432
    ds_read_b128 v[168:171], v30 offset:20480
    ds_read_b128 v[172:175], v30 offset:22528
    ds_read_b64_tr_b16 v[176:177], v38 offset:12288
    ds_read_b64_tr_b16 v[178:179], v38 offset:14336
    ds_read_b64_tr_b16 v[180:181], v39 offset:12288
    ds_read_b64_tr_b16 v[182:183], v39 offset:14336
    ds_read_b64_tr_b16 v[184:185], v38 offset:16384
    ds_read_b64_tr_b16 v[186:187], v38 offset:18432
    ds_read_b64_tr_b16 v[188:189], v39 offset:16384
    ds_read_b64_tr_b16 v[190:191], v39 offset:18432
    s_waitcnt lgkmcnt(10)
    v_swap_b32 v162, v164
    v_swap_b32 v163, v165
    s_waitcnt lgkmcnt(8)
    v_swap_b32 v170, v172
    v_swap_b32 v171, v173
    s_waitcnt lgkmcnt(0)
    v_mfma_f32_16x16x32_bf16 v[224:227], v[176:179], v[160:163], 0
    ds_read_b128 v[192:195], v30 offset:24576
    ds_read_b128 v[196:199], v30 offset:26624
    v_mfma_f32_16x16x32_bf16 v[232:235], v[176:179], v[164:167], 0
    ds_read_b128 v[200:203], v30 offset:28672
    ds_read_b128 v[204:207], v30 offset:30720
    v_mfma_f32_16x16x32_bf16 v[228:231], v[180:183], v[160:163], 0
    ds_read_b64_tr_b16 v[208:209], v38 offset:20480
    ds_read_b64_tr_b16 v[210:211], v38 offset:22528
    v_mfma_f32_16x16x32_bf16 v[236:239], v[180:183], v[164:167], 0
    ds_read_b64_tr_b16 v[212:213], v39 offset:20480
    ds_read_b64_tr_b16 v[214:215], v39 offset:22528
    v_mfma_f32_16x16x32_bf16 v[224:227], v[184:187], v[168:171], v[224:227]
    ds_read_b64_tr_b16 v[216:217], v38 offset:24576
    ds_read_b64_tr_b16 v[218:219], v38 offset:26624
    v_mfma_f32_16x16x32_bf16 v[232:235], v[184:187], v[172:175], v[232:235]
    ds_read_b64_tr_b16 v[220:221], v39 offset:24576
    ds_read_b64_tr_b16 v[222:223], v39 offset:26624
    v_mfma_f32_16x16x32_bf16 v[228:231], v[188:191], v[168:171], v[228:231]
    s_waitcnt lgkmcnt(10)
    v_swap_b32 v194, v196
    v_swap_b32 v195, v197
    v_mfma_f32_16x16x32_bf16 v[236:239], v[188:191], v[172:175], v[236:239]
    s_waitcnt lgkmcnt(8)
    v_swap_b32 v202, v204
    v_swap_b32 v203, v205
    s_waitcnt lgkmcnt(0)
    s_barrier
    v_mfma_f32_16x16x32_bf16 v[224:227], v[208:211], v[192:195], v[224:227]
    ds_read_b128 v[160:163], v30 offset:32768
    ds_read_b128 v[164:167], v30 offset:34816
    v_mfma_f32_16x16x32_bf16 v[232:235], v[208:211], v[196:199], v[232:235]
    ds_read_b128 v[168:171], v30 offset:36864
    ds_read_b128 v[172:175], v30 offset:38912
L_pg7:
    s_cbranch_execz L_warmed
    v_mfma_f32_16x16x32_bf16 v[228:231], v[212:215], v[192:195], v[228:231]
    ds_read_b64_tr_b16 v[176:177], v36 offset:28672
    ds_read_b64_tr_b16 v[178:179], v36 offset:30720
    v_mfma_f32_16x16x32_bf16 v[236:239], v[212:215], v[196:199], v[236:239]
    ds_read_b64_tr_b16 v[180:181], v37 offset:28672
    ds_read_b64_tr_b16 v[182:183], v37 offset:30720
    v_mfma_f32_16x16x32_bf16 v[224:227], v[216:219], v[200:203], v[224:227]
    ds_read_b64_tr_b16 v[184:185], v36 offset:32768
    ds_read_b64_tr_b16 v[186:187], v36 offset:34816
    v_mfma_f32_16x16x32_bf16 v[232:235], v[216:219], v[204:207], v[232:235]
    ds_read_b64_tr_b16 v[188:189], v37 offset:32768
    ds_read_b64_tr_b16 v[190:191], v37 offset:34816
    v_mfma_f32_16x16x32_bf16 v[228:231], v[220:223], v[200:203], v[228:231]
    s_waitcnt lgkmcnt(10)
    v_swap_b32 v162, v164
    v_swap_b32 v163, v165
    v_mfma_f32_16x16x32_bf16 v[236:239], v[220:223], v[204:207], v[236:239]
    s_waitcnt lgkmcnt(8)
    v_swap_b32 v170, v172
    v_swap_b32 v171, v173
    s_waitcnt lgkmcnt(0)
    v_mfma_f32_16x16x32_bf16 v[224:227], v[176:179], v[160:163], v[224:227]
    ds_read_b128 v[192:195], v30 offset:40960
    ds_read_b128 v[196:199], v30 offset:43008
    v_mfma_f32_16x16x32_bf16 v[232:235], v[176:179], v[164:167], v[232:235]
    ds_read_b128 v[200:203], v30 offset:45056
    ds_read_b128 v[204:207], v30 offset:47104
    v_mfma_f32_16x16x32_bf16 v[228:231], v[180:183], v[160:163], v[228:231]
    ds_read_b64_tr_b16 v[208:209], v36 offset:36864
    ds_read_b64_tr_b16 v[210:211], v36 offset:38912
    v_mfma_f32_16x16x32_bf16 v[236:239], v[180:183], v[164:167], v[236:239]
    ds_read_b64_tr_b16 v[212:213], v37 offset:36864
    ds_read_b64_tr_b16 v[214:215], v37 offset:38912
    v_mfma_f32_16x16x32_bf16 v[224:227], v[184:187], v[168:171], v[224:227]
    ds_read_b64_tr_b16 v[216:217], v36 offset:40960
    ds_read_b64_tr_b16 v[218:219], v36 offset:43008
    v_mfma_f32_16x16x32_bf16 v[232:235], v[184:187], v[172:175], v[232:235]
    ds_read_b64_tr_b16 v[220:221], v37 offset:40960
    ds_read_b64_tr_b16 v[222:223], v37 offset:43008
    v_mfma_f32_16x16x32_bf16 v[228:231], v[188:191], v[168:171], v[228:231]
    s_waitcnt lgkmcnt(10)
    v_swap_b32 v194, v196
    v_swap_b32 v195, v197
    v_mfma_f32_16x16x32_bf16 v[236:239], v[188:191], v[172:175], v[236:239]
    s_waitcnt lgkmcnt(8)
    v_swap_b32 v202, v204
    v_swap_b32 v203, v205
    s_waitcnt lgkmcnt(0)
    s_barrier
    v_mfma_f32_16x16x32_bf16 v[224:227], v[208:211], v[192:195], v[224:227]
    ds_read_b128 v[160:163], v30 offset:49152
    ds_read_b128 v[164:167], v30 offset:51200
    v_mfma_f32_16x16x32_bf16 v[232:235], v[208:211], v[196:199], v[232:235]
    ds_read_b128 v[168:171], v30 offset:53248
    ds_read_b128 v[172:175], v30 offset:55296
    v_mfma_f32_16x16x32_bf16 v[228:231], v[212:215], v[192:195], v[228:231]
    ds_read_b64_tr_b16 v[176:177], v36 offset:45056
    ds_read_b64_tr_b16 v[178:179], v36 offset:47104
    v_mfma_f32_16x16x32_bf16 v[236:239], v[212:215], v[196:199], v[236:239]
    ds_read_b64_tr_b16 v[180:181], v37 offset:45056
    ds_read_b64_tr_b16 v[182:183], v37 offset:47104
    v_mfma_f32_16x16x32_bf16 v[224:227], v[216:219], v[200:203], v[224:227]
    ds_read_b64_tr_b16 v[184:185], v36 offset:49152
    ds_read_b64_tr_b16 v[186:187], v36 offset:51200
    v_mfma_f32_16x16x32_bf16 v[232:235], v[216:219], v[204:207], v[232:235]
    ds_read_b64_tr_b16 v[188:189], v37 offset:49152
    ds_read_b64_tr_b16 v[190:191], v37 offset:51200
    v_mfma_f32_16x16x32_bf16 v[228:231], v[220:223], v[200:203], v[228:231]
    s_waitcnt lgkmcnt(10)
    v_swap_b32 v162, v164
    v_swap_b32 v163, v165
    v_mfma_f32_16x16x32_bf16 v[236:239], v[220:223], v[204:207], v[236:239]
    s_waitcnt lgkmcnt(8)
    v_swap_b32 v170, v172
    v_swap_b32 v171, v173
    s_waitcnt lgkmcnt(0)
    s_waitcnt vmcnt(0)
    s_lshl_b32 s82, s72, 3
    s_add_u32 s82, s82, s73
    s_lshl_b32 s82, s82, 4
    s_add_u32 s82, s82, s77
    s_lshl_b32 s82, s82, 2
    s_add_u32 s82, s82, 0xb40000
    v_mov_b32 v6, s78
    v_mov_b32 v4, 0
    s_mov_b64 exec, 1
    buffer_store_dword v6, v4, s[44:47], s82 offen sc1
    s_mov_b64 exec, -1
    v_mfma_f32_16x16x32_bf16 v[224:227], v[176:179], v[160:163], v[224:227]
    ds_read_b128 v[192:195], v30 offset:57344
    ds_read_b128 v[196:199], v30 offset:59392
    v_mfma_f32_16x16x32_bf16 v[232:235], v[176:179], v[164:167], v[232:235]
    ds_read_b128 v[200:203], v30 offset:61440
    ds_read_b128 v[204:207], v30 offset:63488
    v_mfma_f32_16x16x32_bf16 v[228:231], v[180:183], v[160:163], v[228:231]
    ds_read_b64_tr_b16 v[208:209], v36 offset:53248
    ds_read_b64_tr_b16 v[210:211], v36 offset:55296
    v_mfma_f32_16x16x32_bf16 v[236:239], v[180:183], v[164:167], v[236:239]
    ds_read_b64_tr_b16 v[212:213], v37 offset:53248
    ds_read_b64_tr_b16 v[214:215], v37 offset:55296
    v_mfma_f32_16x16x32_bf16 v[224:227], v[184:187], v[168:171], v[224:227]
    ds_read_b64_tr_b16 v[216:217], v36 offset:57344
    ds_read_b64_tr_b16 v[218:219], v36 offset:59392
    v_mfma_f32_16x16x32_bf16 v[232:235], v[184:187], v[172:175], v[232:235]
    ds_read_b64_tr_b16 v[220:221], v37 offset:57344
    ds_read_b64_tr_b16 v[222:223], v37 offset:59392
    v_mfma_f32_16x16x32_bf16 v[228:231], v[188:191], v[168:171], v[228:231]
    s_waitcnt lgkmcnt(10)
    v_swap_b32 v194, v196
    v_swap_b32 v195, v197
    v_mfma_f32_16x16x32_bf16 v[236:239], v[188:191], v[172:175], v[236:239]
    s_waitcnt lgkmcnt(8)
    v_swap_b32 v202, v204
    v_swap_b32 v203, v205
    s_waitcnt lgkmcnt(0)
    s_barrier
    v_mfma_f32_16x16x32_bf16 v[224:227], v[208:211], v[192:195], v[224:227]
    ds_read_b128 v[160:163], v31 offset:0
    ds_read_b128 v[164:167], v31 offset:2048
    v_mfma_f32_16x16x32_bf16 v[232:235], v[208:211], v[196:199], v[232:235]
    ds_read_b128 v[168:171], v31 offset:4096
    ds_read_b128 v[172:175], v31 offset:6144
    v_mfma_f32_16x16x32_bf16 v[228:231], v[212:215], v[192:195], v[228:231]
    ds_read_b64_tr_b16 v[176:177], v36 offset:61440
    ds_read_b64_tr_b16 v[178:179], v36 offset:63488
    v_mfma_f32_16x16x32_bf16 v[236:239], v[212:215], v[196:199], v[236:239]
    ds_read_b64_tr_b16 v[180:181], v37 offset:61440
    ds_read_b64_tr_b16 v[182:183], v37 offset:63488
    v_mfma_f32_16x16x32_bf16 v[224:227], v[216:219], v[200:203], v[224:227]
    ds_read_b64_tr_b16 v[184:185], v38 offset:0
    ds_read_b64_tr_b16 v[186:187], v38 offset:2048
    v_mfma_f32_16x16x32_bf16 v[232:235], v[216:219], v[204:207], v[232:235]
    ds_read_b64_tr_b16 v[188:189], v39 offset:0
    ds_read_b64_tr_b16 v[190:191], v39 offset:2048
    v_mfma_f32_16x16x32_bf16 v[228:231], v[220:223], v[200:203], v[228:231]
    s_waitcnt lgkmcnt(10)
    v_swap_b32 v162, v164
    v_swap_b32 v163, v165
    v_mfma_f32_16x16x32_bf16 v[236:239], v[220:223], v[204:207], v[236:239]
    s_waitcnt lgkmcnt(8)
    v_swap_b32 v170, v172
    v_swap_b32 v171, v173
    s_waitcnt lgkmcnt(0)
    v_mfma_f32_16x16x32_bf16 v[224:227], v[176:179], v[160:163], v[224:227]
    ds_read_b128 v[192:195], v31 offset:8192
    ds_read_b128 v[196:199], v31 offset:10240
    v_mfma_f32_16x16x32_bf16 v[232:235], v[176:179], v[164:167], v[232:235]
    ds_read_b128 v[200:203], v31 offset:12288
    ds_read_b128 v[204:207], v31 offset:14336
    v_mfma_f32_16x16x32_bf16 v[228:231], v[180:183], v[160:163], v[228:231]
    ds_read_b64_tr_b16 v[208:209], v38 offset:4096
    ds_read_b64_tr_b16 v[210:211], v38 offset:6144
    v_mfma_f32_16x16x32_bf16 v[236:239], v[180:183], v[164:167], v[236:239]
    ds_read_b64_tr_b16 v[212:213], v39 offset:4096
    ds_read_b64_tr_b16 v[214:215], v39 offset:6144
    v_mfma_f32_16x16x32_bf16 v[224:227], v[184:187], v[168:171], v[224:227]
    ds_read_b64_tr_b16 v[216:217], v38 offset:8192
    ds_read_b64_tr_b16 v[218:219], v38 offset:10240
    v_mfma_f32_16x16x32_bf16 v[232:235], v[184:187], v[172:175], v[232:235]
    ds_read_b64_tr_b16 v[220:221], v39 offset:8192
    ds_read_b64_tr_b16 v[222:223], v39 offset:10240
    v_mfma_f32_16x16x32_bf16 v[228:231], v[188:191], v[168:171], v[228:231]
    s_waitcnt lgkmcnt(10)
    v_swap_b32 v194, v196
    v_swap_b32 v195, v197
    v_mfma_f32_16x16x32_bf16 v[236:239], v[188:191], v[172:175], v[236:239]
    s_waitcnt lgkmcnt(8)
    v_swap_b32 v202, v204
    v_swap_b32 v203, v205
    s_waitcnt lgkmcnt(0)
    s_barrier
    v_mfma_f32_16x16x32_bf16 v[224:227], v[208:211], v[192:195], v[224:227]
    ds_read_b64_tr_b16 v[24:25], v33 offset:0
    ds_read_b64_tr_b16 v[26:27], v33 offset:2048
    v_mfma_f32_16x16x32_bf16 v[232:235], v[208:211], v[196:199], v[232:235]
    ds_read_b64_tr_b16 v[48:49], v35 offset:0
    ds_read_b64_tr_b16 v[50:51], v35 offset:2048
    v_mfma_f32_16x16x32_bf16 v[228:231], v[212:215], v[192:195], v[228:231]
    ds_read_b64_tr_b16 v[52:53], v33 offset:4096
    ds_read_b64_tr_b16 v[54:55], v33 offset:6144
    v_mfma_f32_16x16x32_bf16 v[236:239], v[212:215], v[196:199], v[236:239]
    ds_read_b64_tr_b16 v[56:57], v35 offset:4096
    ds_read_b64_tr_b16 v[58:59], v35 offset:6144
    v_mfma_f32_16x16x32_bf16 v[224:227], v[216:219], v[200:203], v[224:227]
    ds_read_b64_tr_b16 v[60:61], v33 offset:8192
    ds_read_b64_tr_b16 v[62:63], v33 offset:10240
    v_mfma_f32_16x16x32_bf16 v[232:235], v[216:219], v[204:207], v[232:235]
    ds_read_b64_tr_b16 v[64:65], v35 offset:8192
    ds_read_b64_tr_b16 v[66:67], v35 offset:10240
    v_mfma_f32_16x16x32_bf16 v[228:231], v[220:223], v[200:203], v[228:231]
    ds_read_b64_tr_b16 v[68:69], v33 offset:12288
    ds_read_b64_tr_b16 v[70:71], v33 offset:14336
    v_mfma_f32_16x16x32_bf16 v[236:239], v[220:223], v[204:207], v[236:239]
    ds_read_b64_tr_b16 v[72:73], v35 offset:12288
    ds_read_b64_tr_b16 v[74:75], v35 offset:14336
    s_waitcnt lgkmcnt(0)
    s_barrier
    ds_read_b64_tr_b16 v[76:77], v38 offset:12288
    ds_read_b64_tr_b16 v[78:79], v38 offset:14336
    ds_read_b64_tr_b16 v[80:81], v39 offset:12288
    ds_read_b64_tr_b16 v[82:83], v39 offset:14336
    ds_read_b64_tr_b16 v[84:85], v38 offset:16384
    ds_read_b64_tr_b16 v[86:87], v38 offset:18432
    ds_read_b64_tr_b16 v[88:89], v39 offset:16384
    ds_read_b64_tr_b16 v[90:91], v39 offset:18432
    ds_read_b64_tr_b16 v[92:93], v38 offset:20480
    ds_read_b64_tr_b16 v[94:95], v38 offset:22528
    ds_read_b64_tr_b16 v[96:97], v39 offset:20480
    ds_read_b64_tr_b16 v[98:99], v39 offset:22528
    ds_read_b64_tr_b16 v[100:101], v38 offset:24576
    ds_read_b64_tr_b16 v[102:103], v38 offset:26624
    ds_read_b64_tr_b16 v[104:105], v39 offset:24576
    ds_read_b64_tr_b16 v[106:107], v39 offset:26624
    s_waitcnt lgkmcnt(0)
    s_barrier
    ds_read_b64_tr_b16 v[108:109], v36 offset:28672
    ds_read_b64_tr_b16 v[110:111], v36 offset:30720
    ds_read_b64_tr_b16 v[112:113], v37 offset:28672
    ds_read_b64_tr_b16 v[114:115], v37 offset:30720
    ds_read_b64_tr_b16 v[116:117], v36 offset:32768
    ds_read_b64_tr_b16 v[118:119], v36 offset:34816
    ds_read_b64_tr_b16 v[120:121], v37 offset:32768
    ds_read_b64_tr_b16 v[122:123], v37 offset:34816
    ds_read_b64_tr_b16 v[124:125], v36 offset:36864
    ds_read_b64_tr_b16 v[126:127], v36 offset:38912
    ds_read_b64_tr_b16 v[128:129], v37 offset:36864
    ds_read_b64_tr_b16 v[130:131], v37 offset:38912
    ds_read_b64_tr_b16 v[132:133], v36 offset:40960
    ds_read_b64_tr_b16 v[134:135], v36 offset:43008
    ds_read_b64_tr_b16 v[136:137], v37 offset:40960
    ds_read_b64_tr_b16 v[138:139], v37 offset:43008
    s_waitcnt lgkmcnt(0)
    s_barrier
    ds_read_b64_tr_b16 v[176:177], v36 offset:45056
    ds_read_b64_tr_b16 v[178:179], v36 offset:47104
    ds_read_b64_tr_b16 v[180:181], v37 offset:45056
    ds_read_b64_tr_b16 v[182:183], v37 offset:47104
    ds_read_b64_tr_b16 v[184:185], v36 offset:49152
    ds_read_b64_tr_b16 v[186:187], v36 offset:51200
    ds_read_b64_tr_b16 v[188:189], v37 offset:49152
    ds_read_b64_tr_b16 v[190:191], v37 offset:51200
    ds_read_b64_tr_b16 v[208:209], v36 offset:53248
    ds_read_b64_tr_b16 v[210:211], v36 offset:55296
    ds_read_b64_tr_b16 v[212:213], v37 offset:53248
    ds_read_b64_tr_b16 v[214:215], v37 offset:55296
    ds_read_b64_tr_b16 v[216:217], v36 offset:57344
    ds_read_b64_tr_b16 v[218:219], v36 offset:59392
    ds_read_b64_tr_b16 v[220:221], v37 offset:57344
    ds_read_b64_tr_b16 v[222:223], v37 offset:59392
    v_mov_b32 v6, 0xbfb8aa3b
    s_waitcnt lgkmcnt(0)
    s_barrier
    ds_read_b128 v[140:143], v30 offset:16384
    ds_read_b128 v[144:147], v30 offset:18432
    ds_read_b128 v[148:151], v30 offset:20480
    ds_read_b128 v[152:155], v30 offset:22528
    ds_read_b128 v[160:163], v30 offset:24576
    ds_read_b128 v[164:167], v30 offset:26624
    ds_read_b128 v[168:171], v30 offset:28672
    ds_read_b128 v[172:175], v30 offset:30720
    s_waitcnt lgkmcnt(6)
    v_swap_b32 v142, v144
    v_swap_b32 v143, v145
    s_waitcnt lgkmcnt(4)
    v_swap_b32 v150, v152
    v_swap_b32 v151, v153
    s_barrier
    s_waitcnt lgkmcnt(0)
    v_mfma_f32_16x16x32_bf16 v[8:11], v[24:27], v[140:143], 0
    v_swap_b32 v162, v164
    v_mfma_f32_16x16x32_bf16 v[16:19], v[24:27], v[144:147], 0
    ds_read_b128 v[192:195], v30 offset:32768
    ds_read_b128 v[196:199], v30 offset:34816
    v_mfma_f32_16x16x32_bf16 v[12:15], v[48:51], v[140:143], 0
    v_swap_b32 v163, v165
    v_mfma_f32_16x16x32_bf16 v[20:23], v[48:51], v[144:147], 0
    ds_read_b128 v[200:203], v30 offset:36864
    ds_read_b128 v[204:207], v30 offset:38912
    v_mfma_f32_16x16x32_bf16 v[8:11], v[52:55], v[148:151], v[8:11]
    v_swap_b32 v170, v172
    v_mfma_f32_16x16x32_bf16 v[16:19], v[52:55], v[152:155], v[16:19]
    v_mfma_f32_16x16x32_bf16 v[12:15], v[56:59], v[148:151], v[12:15]
    v_swap_b32 v171, v173
    v_mfma_f32_16x16x32_bf16 v[20:23], v[56:59], v[152:155], v[20:23]
    s_waitcnt lgkmcnt(0)
    v_mfma_f32_16x16x32_bf16 v[8:11], v[60:63], v[160:163], v[8:11]
    v_swap_b32 v194, v196
    v_mfma_f32_16x16x32_bf16 v[16:19], v[60:63], v[164:167], v[16:19]
    ds_read_b128 v[140:143], v30 offset:40960
    ds_read_b128 v[144:147], v30 offset:43008
    v_mfma_f32_16x16x32_bf16 v[12:15], v[64:67], v[160:163], v[12:15]
    v_swap_b32 v195, v197
    v_mfma_f32_16x16x32_bf16 v[20:23], v[64:67], v[164:167], v[20:23]
    ds_read_b128 v[148:151], v30 offset:45056
    ds_read_b128 v[152:155], v30 offset:47104
    v_mfma_f32_16x16x32_bf16 v[8:11], v[68:71], v[168:171], v[8:11]
    v_swap_b32 v202, v204
    v_mfma_f32_16x16x32_bf16 v[16:19], v[68:71], v[172:175], v[16:19]
    v_mfma_f32_16x16x32_bf16 v[12:15], v[72:75], v[168:171], v[12:15]
    v_swap_b32 v203, v205
    v_mfma_f32_16x16x32_bf16 v[20:23], v[72:75], v[172:175], v[20:23]
    s_barrier
    s_waitcnt lgkmcnt(0)
    v_mfma_f32_16x16x32_bf16 v[8:11], v[76:79], v[192:195], v[8:11]
    v_swap_b32 v142, v144
    v_mfma_f32_16x16x32_bf16 v[16:19], v[76:79], v[196:199], v[16:19]
    ds_read_b128 v[160:163], v30 offset:49152
    ds_read_b128 v[164:167], v30 offset:51200
    v_mfma_f32_16x16x32_bf16 v[12:15], v[80:83], v[192:195], v[12:15]
    v_swap_b32 v143, v145
    v_mfma_f32_16x16x32_bf16 v[20:23], v[80:83], v[196:199], v[20:23]
    ds_read_b128 v[168:171], v30 offset:53248
    ds_read_b128 v[172:175], v30 offset:55296
    v_mfma_f32_16x16x32_bf16 v[8:11], v[84:87], v[200:203], v[8:11]
    v_swap_b32 v150, v152
    v_mfma_f32_16x16x32_bf16 v[16:19], v[84:87], v[204:207], v[16:19]
    ds_read_b64_tr_b16 v[24:25], v36 offset:61440
    ds_read_b64_tr_b16 v[26:27], v36 offset:63488
    v_mfma_f32_16x16x32_bf16 v[12:15], v[88:91], v[200:203], v[12:15]
    v_swap_b32 v151, v153
    ds_read_b64_tr_b16 v[48:49], v37 offset:61440
    ds_read_b64_tr_b16 v[50:51], v37 offset:63488
    v_mfma_f32_16x16x32_bf16 v[20:23], v[88:91], v[204:207], v[20:23]
    s_waitcnt lgkmcnt(4)
    v_mfma_f32_16x16x32_bf16 v[8:11], v[92:95], v[140:143], v[8:11]
    v_swap_b32 v162, v164
    v_mfma_f32_16x16x32_bf16 v[16:19], v[92:95], v[144:147], v[16:19]
    ds_read_b128 v[192:195], v30 offset:57344
    ds_read_b128 v[196:199], v30 offset:59392
    v_mfma_f32_16x16x32_bf16 v[12:15], v[96:99], v[140:143], v[12:15]
    v_swap_b32 v163, v165
    v_mfma_f32_16x16x32_bf16 v[20:23], v[96:99], v[144:147], v[20:23]
    ds_read_b128 v[200:203], v30 offset:61440
    ds_read_b128 v[204:207], v30 offset:63488
    v_mfma_f32_16x16x32_bf16 v[8:11], v[100:103], v[148:151], v[8:11]
    v_swap_b32 v170, v172
    v_mfma_f32_16x16x32_bf16 v[16:19], v[100:103], v[152:155], v[16:19]
    ds_read_b64_tr_b16 v[52:53], v38 offset:0
    ds_read_b64_tr_b16 v[54:55], v38 offset:2048
    v_mfma_f32_16x16x32_bf16 v[12:15], v[104:107], v[148:151], v[12:15]
    v_swap_b32 v171, v173
    ds_read_b64_tr_b16 v[56:57], v39 offset:0
    ds_read_b64_tr_b16 v[58:59], v39 offset:2048
    v_mfma_f32_16x16x32_bf16 v[20:23], v[104:107], v[152:155], v[20:23]
    s_barrier
    s_waitcnt lgkmcnt(4)
    v_mfma_f32_16x16x32_bf16 v[8:11], v[108:111], v[160:163], v[8:11]
    v_swap_b32 v194, v196
    v_mfma_f32_16x16x32_bf16 v[16:19], v[108:111], v[164:167], v[16:19]
    ds_read_b128 v[140:143], v31 offset:0
    ds_read_b128 v[144:147], v31 offset:2048
    v_mfma_f32_16x16x32_bf16 v[12:15], v[112:115], v[160:163], v[12:15]
    v_swap_b32 v195, v197
    v_mfma_f32_16x16x32_bf16 v[20:23], v[112:115], v[164:167], v[20:23]
    ds_read_b128 v[148:151], v31 offset:4096
    ds_read_b128 v[152:155], v31 offset:6144
    v_mfma_f32_16x16x32_bf16 v[8:11], v[116:119], v[168:171], v[8:11]
    v_swap_b32 v202, v204
    v_mfma_f32_16x16x32_bf16 v[16:19], v[116:119], v[172:175], v[16:19]
    ds_read_b64_tr_b16 v[60:61], v38 offset:4096
    ds_read_b64_tr_b16 v[62:63], v38 offset:6144
    v_mfma_f32_16x16x32_bf16 v[12:15], v[120:123], v[168:171], v[12:15]
    v_swap_b32 v203, v205
    ds_read_b64_tr_b16 v[64:65], v39 offset:4096
    ds_read_b64_tr_b16 v[66:67], v39 offset:6144
    v_mfma_f32_16x16x32_bf16 v[20:23], v[120:123], v[172:175], v[20:23]
    s_waitcnt lgkmcnt(4)
    v_mfma_f32_16x16x32_bf16 v[8:11], v[124:127], v[192:195], v[8:11]
    v_swap_b32 v142, v144
    v_mfma_f32_16x16x32_bf16 v[16:19], v[124:127], v[196:199], v[16:19]
    ds_read_b128 v[160:163], v31 offset:8192
    ds_read_b128 v[164:167], v31 offset:10240
    v_mfma_f32_16x16x32_bf16 v[12:15], v[128:131], v[192:195], v[12:15]
    v_swap_b32 v143, v145
    v_mfma_f32_16x16x32_bf16 v[20:23], v[128:131], v[196:199], v[20:23]
    ds_read_b128 v[168:171], v31 offset:12288
    ds_read_b128 v[172:175], v31 offset:14336
    v_mfma_f32_16x16x32_bf16 v[8:11], v[132:135], v[200:203], v[8:11]
    v_swap_b32 v150, v152
    v_mfma_f32_16x16x32_bf16 v[16:19], v[132:135], v[204:207], v[16:19]
    ds_read_b64_tr_b16 v[68:69], v38 offset:8192
    ds_read_b64_tr_b16 v[70:71], v38 offset:10240
    v_mfma_f32_16x16x32_bf16 v[12:15], v[136:139], v[200:203], v[12:15]
    v_swap_b32 v151, v153
    ds_read_b64_tr_b16 v[72:73], v39 offset:8192
    ds_read_b64_tr_b16 v[74:75], v39 offset:10240
    v_mfma_f32_16x16x32_bf16 v[20:23], v[136:139], v[204:207], v[20:23]
    s_barrier
    s_waitcnt lgkmcnt(4)
    v_mfma_f32_16x16x32_bf16 v[8:11], v[176:179], v[140:143], v[8:11]
    v_swap_b32 v162, v164
    v_mfma_f32_16x16x32_bf16 v[16:19], v[176:179], v[144:147], v[16:19]
    ds_read_b128 v[192:195], v30 offset:0
    ds_read_b128 v[196:199], v30 offset:2048
    v_mfma_f32_16x16x32_bf16 v[12:15], v[180:183], v[140:143], v[12:15]
    v_swap_b32 v163, v165
    v_mfma_f32_16x16x32_bf16 v[20:23], v[180:183], v[144:147], v[20:23]
    ds_read_b128 v[200:203], v30 offset:4096
    ds_read_b128 v[204:207], v30 offset:6144
    v_mfma_f32_16x16x32_bf16 v[8:11], v[184:187], v[148:151], v[8:11]
    v_swap_b32 v170, v172
    v_mfma_f32_16x16x32_bf16 v[16:19], v[184:187], v[152:155], v[16:19]
    ds_read_b64_tr_b16 v[76:77], v36 offset:16384
    ds_read_b64_tr_b16 v[78:79], v36 offset:18432
    v_mfma_f32_16x16x32_bf16 v[12:15], v[188:191], v[148:151], v[12:15]
    v_swap_b32 v171, v173
    ds_read_b64_tr_b16 v[80:81], v37 offset:16384
    ds_read_b64_tr_b16 v[82:83], v37 offset:18432
    v_mfma_f32_16x16x32_bf16 v[20:23], v[188:191], v[152:155], v[20:23]
    s_waitcnt lgkmcnt(4)
    v_mfma_f32_16x16x32_bf16 v[8:11], v[208:211], v[160:163], v[8:11]
    v_swap_b32 v194, v196
    v_mfma_f32_16x16x32_bf16 v[16:19], v[208:211], v[164:167], v[16:19]
    ds_read_b128 v[140:143], v30 offset:8192
    ds_read_b128 v[144:147], v30 offset:10240
    v_mfma_f32_16x16x32_bf16 v[12:15], v[212:215], v[160:163], v[12:15]
    v_swap_b32 v195, v197
    v_mfma_f32_16x16x32_bf16 v[20:23], v[212:215], v[164:167], v[20:23]
    ds_read_b128 v[148:151], v30 offset:12288
    ds_read_b128 v[152:155], v30 offset:14336
    v_mfma_f32_16x16x32_bf16 v[8:11], v[216:219], v[168:171], v[8:11]
    v_swap_b32 v202, v204
    v_mfma_f32_16x16x32_bf16 v[16:19], v[216:219], v[172:175], v[16:19]
    ds_read_b64_tr_b16 v[84:85], v36 offset:20480
    ds_read_b64_tr_b16 v[88:89], v37 offset:20480
    v_mfma_f32_16x16x32_bf16 v[12:15], v[220:223], v[168:171], v[12:15]
    v_swap_b32 v203, v205
    v_mfma_f32_16x16x32_bf16 v[20:23], v[220:223], v[172:175], v[20:23]
    s_barrier
    s_waitcnt lgkmcnt(2)
    v_mfma_f32_16x16x32_bf16 v[8:11], v[24:27], v[192:195], v[8:11]
    v_swap_b32 v142, v144
    v_mfma_f32_16x16x32_bf16 v[16:19], v[24:27], v[196:199], v[16:19]
    ds_read_b128 v[160:163], v32 offset:12288
    ds_read_b128 v[164:167], v32 offset:14336
    v_mfma_f32_16x16x32_bf16 v[12:15], v[48:51], v[192:195], v[12:15]
    v_swap_b32 v143, v145
    v_mfma_f32_16x16x32_bf16 v[20:23], v[48:51], v[196:199], v[20:23]
    ds_read_b128 v[168:171], v32 offset:16384
    ds_read_b64 v[92:93], v5 offset:0
    v_mfma_f32_16x16x32_bf16 v[8:11], v[52:55], v[200:203], v[8:11]
    v_swap_b32 v150, v152
    v_mfma_f32_16x16x32_bf16 v[16:19], v[52:55], v[204:207], v[16:19]
    ds_read_b64 v[96:97], v46 offset:0
    ds_read_b64 v[100:101], v5 offset:128
    v_mfma_f32_16x16x32_bf16 v[12:15], v[56:59], v[200:203], v[12:15]
    v_swap_b32 v151, v153
    ds_read_b64 v[104:105], v46 offset:128
    v_mfma_f32_16x16x32_bf16 v[20:23], v[56:59], v[204:207], v[20:23]
    s_waitcnt lgkmcnt(4)
    v_mfma_f32_16x16x32_bf16 v[8:11], v[60:63], v[140:143], v[8:11]
    v_swap_b32 v162, v164
    v_mfma_f32_16x16x32_bf16 v[16:19], v[60:63], v[144:147], v[16:19]
    s_waitcnt lgkmcnt(3)
    v_and_b32 v95, 0xffff0000, v93
    v_lshlrev_b32 v94, 16, v93
    v_mfma_f32_16x16x32_bf16 v[12:15], v[64:67], v[140:143], v[12:15]
    v_swap_b32 v163, v165
    v_and_b32 v93, 0xffff0000, v92
    v_lshlrev_b32 v92, 16, v92
    v_mfma_f32_16x16x32_bf16 v[20:23], v[64:67], v[144:147], v[20:23]
    s_waitcnt lgkmcnt(2)
    v_and_b32 v99, 0xffff0000, v97
    v_lshlrev_b32 v98, 16, v97
    v_mfma_f32_16x16x32_bf16 v[8:11], v[68:71], v[148:151], v[8:11]
    v_and_b32 v97, 0xffff0000, v96
    v_lshlrev_b32 v96, 16, v96
    v_mfma_f32_16x16x32_bf16 v[16:19], v[68:71], v[152:155], v[16:19]
    v_mfma_f32_16x16x32_bf16 v[12:15], v[72:75], v[148:151], v[12:15]
    v_mfma_f32_16x16x32_bf16 v[20:23], v[72:75], v[152:155], v[20:23]
    v_mfma_f32_16x16x32_bf16 v[8:11], v[76:79], v[160:163], v[8:11]
    s_waitcnt lgkmcnt(1)
    v_and_b32 v103, 0xffff0000, v101
    v_lshlrev_b32 v102, 16, v101
    v_mfma_f32_16x16x32_bf16 v[16:19], v[76:79], v[164:167], v[16:19]
    v_and_b32 v101, 0xffff0000, v100
    v_lshlrev_b32 v100, 16, v100
    v_mfma_f32_16x16x32_bf16 v[12:15], v[80:83], v[160:163], v[12:15]
    s_waitcnt lgkmcnt(0)
    v_and_b32 v107, 0xffff0000, v105
    v_lshlrev_b32 v106, 16, v105
    v_mfma_f32_16x16x32_bf16 v[20:23], v[80:83], v[164:167], v[20:23]
    v_and_b32 v105, 0xffff0000, v104
    v_lshlrev_b32 v104, 16, v104
    v_mfma_f32_16x16x16_bf16 v[8:11], v[84:85], v[168:169], v[8:11]
    v_mfma_f32_16x16x16_bf16 v[16:19], v[84:85], v[170:171], v[16:19]
    v_mfma_f32_16x16x16_bf16 v[12:15], v[88:89], v[168:169], v[12:15]
    v_mfma_f32_16x16x16_bf16 v[20:23], v[88:89], v[170:171], v[20:23]
    s_nop 4
    v_pk_mul_f32 v[192:193], v[8:9], v[6:7] op_sel_hi:[1,0]
    v_pk_mul_f32 v[194:195], v[10:11], v[6:7] op_sel_hi:[1,0]
    v_pk_mul_f32 v[196:197], v[12:13], v[6:7] op_sel_hi:[1,0]
    v_pk_mul_f32 v[198:199], v[14:15], v[6:7] op_sel_hi:[1,0]
    v_exp_f32 v192, v192
    v_exp_f32 v193, v193
    v_exp_f32 v194, v194
    v_exp_f32 v195, v195
    v_exp_f32 v196, v196
    v_exp_f32 v197, v197
    v_exp_f32 v198, v198
    v_exp_f32 v199, v199
    v_pk_mul_f32 v[8:9], v[8:9], v[224:225]
    v_pk_mul_f32 v[10:11], v[10:11], v[226:227]
    v_pk_mul_f32 v[12:13], v[12:13], v[228:229]
    v_pk_mul_f32 v[14:15], v[14:15], v[230:231]
    v_pk_add_f32 v[192:193], v[192:193], 1.0 op_sel_hi:[1,0]
    v_pk_add_f32 v[194:195], v[194:195], 1.0 op_sel_hi:[1,0]
    v_pk_add_f32 v[196:197], v[196:197], 1.0 op_sel_hi:[1,0]
    v_pk_add_f32 v[198:199], v[198:199], 1.0 op_sel_hi:[1,0]
    v_rcp_f32 v192, v192
    v_rcp_f32 v193, v193
    v_rcp_f32 v194, v194
    v_rcp_f32 v195, v195
    v_rcp_f32 v196, v196
    v_rcp_f32 v197, v197
    v_rcp_f32 v198, v198
    v_rcp_f32 v199, v199
    v_pk_fma_f32 v[192:193], v[192:193], v[8:9], v[92:93]
    v_pk_fma_f32 v[194:195], v[194:195], v[10:11], v[94:95]
    v_pk_fma_f32 v[196:197], v[196:197], v[12:13], v[96:97]
    v_pk_fma_f32 v[198:199], v[198:199], v[14:15], v[98:99]
    v_cvt_pk_bf16_f32 v200, v192, v193
    v_cvt_pk_bf16_f32 v201, v194, v195
    ds_write_b64 v44, v[200:201] offset:0
    v_cvt_pk_bf16_f32 v202, v196, v197
    v_cvt_pk_bf16_f32 v203, v198, v199
    ds_write_b64 v44, v[202:203] offset:32
    v_pk_mul_f32 v[140:141], v[16:17], v[6:7] op_sel_hi:[1,0]
    v_pk_mul_f32 v[142:143], v[18:19], v[6:7] op_sel_hi:[1,0]
    v_pk_mul_f32 v[144:145], v[20:21], v[6:7] op_sel_hi:[1,0]
    v_pk_mul_f32 v[146:147], v[22:23], v[6:7] op_sel_hi:[1,0]
    v_exp_f32 v140, v140
    v_exp_f32 v141, v141
    v_exp_f32 v142, v142
    v_exp_f32 v143, v143
    v_exp_f32 v144, v144
    v_exp_f32 v145, v145
    v_exp_f32 v146, v146
    v_exp_f32 v147, v147
    s_waitcnt lgkmcnt(0)
    s_barrier
    ds_read_b128 v[204:207], v45
    v_pk_mul_f32 v[16:17], v[16:17], v[232:233]
    v_pk_mul_f32 v[18:19], v[18:19], v[234:235]
    v_pk_mul_f32 v[20:21], v[20:21], v[236:237]
    v_pk_mul_f32 v[22:23], v[22:23], v[238:239]
    v_pk_add_f32 v[140:141], v[140:141], 1.0 op_sel_hi:[1,0]
    v_pk_add_f32 v[142:143], v[142:143], 1.0 op_sel_hi:[1,0]
    v_pk_add_f32 v[144:145], v[144:145], 1.0 op_sel_hi:[1,0]
    v_pk_add_f32 v[146:147], v[146:147], 1.0 op_sel_hi:[1,0]
    v_rcp_f32 v140, v140
    v_rcp_f32 v141, v141
    v_rcp_f32 v142, v142
    v_rcp_f32 v143, v143
    v_rcp_f32 v144, v144
    v_rcp_f32 v145, v145
    v_rcp_f32 v146, v146
    v_rcp_f32 v147, v147
    s_waitcnt lgkmcnt(0)
    buffer_store_dwordx4 v[204:207], v42, s[36:39], s92 offen sc1
    v_pk_fma_f32 v[140:141], v[140:141], v[16:17], v[100:101]
    v_pk_fma_f32 v[142:143], v[142:143], v[18:19], v[102:103]
    v_pk_fma_f32 v[144:145], v[144:145], v[20:21], v[104:105]
    v_pk_fma_f32 v[146:147], v[146:147], v[22:23], v[106:107]
    v_cvt_pk_bf16_f32 v148, v140, v141
    v_cvt_pk_bf16_f32 v149, v142, v143
    ds_write_b64 v44, v[148:149] offset:2304
    v_cvt_pk_bf16_f32 v150, v144, v145
    v_cvt_pk_bf16_f32 v151, v146, v147
    ds_write_b64 v44, v[150:151] offset:2336
    s_waitcnt lgkmcnt(0)
    s_barrier
    ds_read_b128 v[152:155], v45 offset:2304
    s_waitcnt lgkmcnt(0)
    buffer_store_dwordx4 v[152:155], v42, s[36:39], s92 offen offset:1024 sc1
L_end:
    s_endpgm
.section .rodata,"a"
.p2align 6
.amdhsa_kernel recurrent_scan__sliding_local_dilated__mixer_gmlp__prompt_kernel
  .amdhsa_next_free_vgpr 256
  .amdhsa_next_free_sgpr 102
  .amdhsa_accum_offset 256
  .amdhsa_group_segment_fixed_size 0
  .amdhsa_kernarg_size 88
  .amdhsa_user_sgpr_count 2
  .amdhsa_user_sgpr_kernarg_segment_ptr 1
  .amdhsa_system_sgpr_workgroup_id_x 1
.end_amdhsa_kernel
```
